```python
import torch

def _softmax(x, axis=-1):
    return torch.softmax(x, dim=axis)
def _gelu(x):
    return torch.nn.functional.gelu(x, approximate="tanh")
def _silu(x):
    return torch.nn.functional.silu(x)
def _sigmoid(x):
    return torch.sigmoid(x)
def _layernorm(x, axis=-1, eps=1e-5):
    m = x.mean(dim=axis, keepdim=True)
    v = x.var(dim=axis, keepdim=True, unbiased=False)
    return (x - m) / torch.sqrt(v + eps)
def _scatter_add(tgt, idx, src, axis=0):
    return tgt.clone().index_add_(axis, idx, src)
def _segment_sum(src, seg, n):
    out = torch.zeros((n,) + src.shape[1:], dtype=src.dtype)
    return out.index_add_(0, seg, src)
def _pad(x, pw):
    flat = tuple(v for pair in reversed(pw) for v in pair)
    return torch.nn.functional.pad(x, flat)

kernel_name = 'recurrent_scan__spectral_gfnet__glu_gated_geglu__prompt'

def setup_inputs():

    _w = (lambda a: (lambda t: t.to(torch.bfloat16) if t.is_floating_point() else t)(torch.as_tensor(a)))
    def _A_setup():
        B, S, D = 1, 2048, 512
        Df = D // 2 + 1
        return {
            "x": _w((lambda *s: torch.randn(*s, dtype=torch.bfloat16) * 0.2)(B, S, D)),
            "w_r": _w((lambda *s: torch.randn(*s, dtype=torch.bfloat16) * 1.6)(S, Df) * 0.02),
            "w_i": _w((lambda *s: torch.randn(*s, dtype=torch.bfloat16) * 1.6)(S, Df) * 0.02),
        }
    _A_in = _A_setup()

    def _B_setup():
        B, S, Dm, Df = 1, 2048, 512, 1792
        return {
            "x": _w((lambda *s: torch.randn(*s, dtype=torch.bfloat16) * 0.2)(B, S, Dm)),
            "w_gate": _w((lambda *s: torch.randn(*s, dtype=torch.bfloat16) * 0.8)(Dm, Df) * (Dm ** -0.5)),
            "w_up": _w((lambda *s: torch.randn(*s, dtype=torch.bfloat16) * 0.8)(Dm, Df) * (Dm ** -0.5)),
            "w_down": _w((lambda *s: torch.randn(*s, dtype=torch.bfloat16) * 0.8)(Df, Dm) * (Df ** -0.5)),
        }
    _B_in = _B_setup()

    return {
        "A_x": _A_in["x"],
        "A_w_r": _A_in["w_r"],
        "A_w_i": _A_in["w_i"],
        "B_x": _B_in["x"],
        "B_w_gate": _B_in["w_gate"],
        "B_w_up": _B_in["w_up"],
        "B_w_down": _B_in["w_down"],
    }

def reference(A_x, A_w_r, A_w_i, B_x, B_w_gate, B_w_up, B_w_down):
    def _A_ref(x, w_r, w_i):
        B, S, D = x.shape
        X = (lambda x, axes=(-2,-1): torch.fft.rfft2(x.float(), dim=axes))(x, axes=(-2, -1))
        W = w_r + 1j * w_i
        X = X * W
        y = (lambda x, s, axes=(-2,-1): torch.fft.irfft2(x, s=s, dim=axes).to(torch.bfloat16))(X, (S, D), axes=(-2, -1))
        return y

    def _B_ref(x, w_gate, w_up, w_down):
        g = torch.einsum("bsd,df->bsf", x, w_gate)
        u = torch.einsum("bsd,df->bsf", x, w_up)
        h = _gelu(g) * u
        return torch.einsum("bsf,fd->bsd", h, w_down)

    x = A_x
    xn = _layernorm(x, axis=-1)
    s = _A_ref(xn, A_w_r, A_w_i)
    g = _silu(_B_ref(xn, B_w_gate, B_w_up, B_w_down))
    return x + s * g
```

```asm
; @launch grid=(256,1,1) block=(256,1,1) lds=163840
.amdgcn_target "amdgcn-amd-amdhsa--gfx950"
.text
.globl recurrent_scan__spectral_gfnet__glu_gated_geglu__prompt_kernel
.p2align 8
.type recurrent_scan__spectral_gfnet__glu_gated_geglu__prompt_kernel,@function
recurrent_scan__spectral_gfnet__glu_gated_geglu__prompt_kernel:
    s_cmp_ge_u32 s2, 256
    s_cbranch_scc1 L_end
    s_load_dwordx16 s[64:79], s[0:1], 0
    s_load_dwordx2 s[36:37], s[0:1], 72
    v_lshrrev_b32 v2, 6, v0
    v_and_b32 v1, 63, v0
    s_getpc_b64 s[62:63]
L_pc:
    v_readfirstlane_b32 s3, v2
    v_lshlrev_b32 v12, 7, v1
    s_lshr_b32 s42, s2, 3
    s_and_b32 s56, s42, 7
    s_lshl_b32 s56, s56, 2
    s_add_u32 s56, s56, s3
    s_mul_i32 s56, s56, 1664
    v_add_u32 v12, s56, v12
    v_min_u32 v12, L_code_end-L_pc-16, v12
    s_mov_b64 exec, 0x1fff
    global_load_dword v44, v12, s[62:63]
    s_mov_b64 exec, -1
    v_lshlrev_b32 v2, 4, v1
    s_and_b32 s41, s2, 7
    s_and_b32 s56, s42, 3
    s_lshr_b32 s44, s42, 2
    s_lshl_b32 s45, s56, 1
    s_lshr_b32 s57, s41, 1
    s_mul_i32 s43, s57, 7
    s_add_u32 s43, s43, s56
    s_and_b32 s58, s41, 1
    s_mul_i32 s59, s58, 3
    s_add_u32 s43, s43, s59
    s_lshl_b32 s58, s58, 2
    s_or_b32 s58, s58, s56
    s_cmp_eq_u32 s58, 3
    s_cselect_b32 s43, s57, s43
    s_cselect_b32 s47, 1, 0
    s_cselect_b32 s46, 0, s44
    s_mov_b32 s45, 0
    s_lshl_b32 s50, s41, 5
    s_add_u32 s50, s50, s42
    s_and_b32 s56, s50, 1
    s_lshl_b32 s56, s56, 4
    s_lshr_b32 s57, s3, 1
    s_lshl_b32 s57, s57, 3
    s_or_b32 s56, s56, s57
    s_and_b32 s57, s50, 2
    s_lshl_b32 s57, s57, 1
    s_or_b32 s56, s56, s57
    s_and_b32 s57, s3, 1
    s_lshl_b32 s57, s57, 1
    s_or_b32 s56, s56, s57
    s_lshl_b32 s56, s56, 16
    s_lshr_b32 s57, s50, 2
    s_lshl_b32 s57, s57, 10
    s_add_u32 s56, s56, s57
    s_add_u32 s57, s56, 65536
    s_mov_b32 s10, 2097152
    s_mov_b32 s11, 0x20000
    s_mov_b32 s14, 1835008
    s_mov_b32 s15, 0x20000
    s_mov_b32 s18, 1835008
    s_mov_b32 s19, 0x20000
    v_lshrrev_b32 v12, 3, v1
    v_and_b32 v13, 7, v1
    v_and_b32 v14, 2, v12
    v_xor_b32 v13, v13, v14
    v_mul_u32_u24 v12, 3584, v12
    v_lshl_add_u32 v5, v13, 4, v12
    v_xor_b32 v13, 4, v13
    v_lshl_add_u32 v6, v13, 4, v12
    s_mul_i32 s88, s3, 57344
    s_lshl_b32 s58, s43, 7
    s_add_u32 s88, s88, s58
    s_lshl_b32 s89, s3, 11
    s_waitcnt lgkmcnt(0)
    s_mov_b32 s8, s64
    s_mov_b32 s9, s65
    buffer_load_dwordx4 v[16:19], v2, s[8:11], s56 offen
    buffer_load_dwordx4 v[20:23], v2, s[8:11], s57 offen
    s_load_dword s40, s[36:37], 0
    s_mov_b32 s12, s72
    s_mov_b32 s13, s73
    s_mov_b32 s16, s74
    s_mov_b32 s17, s75
    s_cmp_eq_u32 s47, 1
    s_cbranch_scc1 L_dft
    s_add_u32 s86, s46, 0
    s_and_b32 s86, s86, 7
    s_mul_i32 s86, s86, 229376
    s_add_u32 s86, s86, s88
    s_add_u32 s87, s86, 28672
    s_add_u32 m0, s89, 0
    s_nop 0
    buffer_load_dwordx4 v5, s[12:15], s86 offen nt lds
    s_add_u32 m0, s89, 1024
    s_nop 0
    buffer_load_dwordx4 v5, s[12:15], s87 offen nt lds
    s_add_u32 m0, s89, 8192
    s_nop 0
    buffer_load_dwordx4 v6, s[16:19], s86 offen nt lds
    s_add_u32 m0, s89, 9216
    s_nop 0
    buffer_load_dwordx4 v6, s[16:19], s87 offen nt lds
    s_mov_b32 s24, s66
    s_mov_b32 s25, s67
    s_mov_b32 s28, s68
    s_mov_b32 s29, s69
    s_mov_b32 s20, s76
    s_mov_b32 s21, s77
    s_mov_b32 s32, s78
    s_mov_b32 s33, s79
    s_mov_b32 s26, 1052672
    s_mov_b32 s27, 0x20000
    s_mov_b32 s30, 1052672
    s_mov_b32 s31, 0x20000
    s_mov_b32 s22, 1835008
    s_mov_b32 s23, 0x20000
    s_mov_b32 s34, 2097152
    s_mov_b32 s35, 0x20000
    s_mov_b32 s38, 16777216
    s_mov_b32 s39, 0x20000
    s_mov_b32 s54, 400000
    s_mov_b32 s1, s50
    s_lshl_b32 s58, s46, 3
    v_add_u32 v8, s58, v1
    v_and_b32 v8, 63, v8
    v_lshlrev_b32 v8, 4, v8
    v_add_u32 v9, 64496, v8
    v_add_u32 v10, 128992, v8
    v_add_u32 v11, 193488, v8
    s_and_b32 s58, s3, 1
    s_lshl_b32 s58, s58, 20
    s_lshr_b32 s59, s3, 1
    s_lshl_b32 s59, s59, 18
    s_or_b32 s48, s58, s59
    s_lshl_b32 s58, s44, 13
    s_add_u32 s48, s48, s58
    s_mul_i32 s49, s3, 8320
    s_and_b32 s58, s41, 1
    s_mul_i32 s58, s58, 3
    s_add_u32 s58, s58, s42
    s_and_b32 s58, s58, 3
    s_mov_b32 s45, 0x32765410
    s_cmp_eq_u32 s58, 1
    s_cselect_b32 s45, 0x54327610, s45
    s_cmp_eq_u32 s58, 2
    s_cselect_b32 s45, 0x76543210, s45
    s_cmp_eq_u32 s58, 3
    s_cselect_b32 s45, 0x10765432, s45
    s_and_b32 s58, s45, 15
    s_lshl_b32 s58, s58, 10
    s_add_u32 s64, s48, s58
    s_add_u32 s65, s64, 1024
    s_cmp_eq_u32 s1, 255
    s_mov_b32 s0, 0x36000000
    s_cselect_b32 s0, 0x35800000, s0
    v_and_b32 v204, 15, v1
    v_lshrrev_b32 v205, 4, v1
    v_cvt_f32_u32 v204, v204
    v_cvt_f32_u32 v205, v205
    s_lshl_b32 s60, s3, 4
    v_cvt_f32_u32 v206, s60
    v_add_f32 v207, 0x00000000, v204
    v_mul_f32 v207, 0x3d000000, v207
    v_mul_f32 v208, 4.0, v205
    v_mul_f32 v208, v208, v207
    v_fmamk_f32 v210, v207, 0x00000000, v208
    v_fmamk_f32 v211, v207, 0x3f800000, v208
    v_cos_f32 v212, v210
    v_cos_f32 v213, v211
    v_sin_f32 v214, v210
    v_sin_f32 v215, v211
    v_cvt_pk_bf16_f32 v210, v212, v213
    v_cvt_pk_bf16_f32 v211, v214, v215
    v_accvgpr_write_b32 a176, v210
    v_accvgpr_write_b32 a184, v211
    v_xor_b32 v211, 0x80008000, v211
    v_accvgpr_write_b32 a192, v211
    v_fmamk_f32 v216, v207, 0x40000000, v208
    v_fmamk_f32 v217, v207, 0x40400000, v208
    v_cos_f32 v218, v216
    v_cos_f32 v219, v217
    v_sin_f32 v220, v216
    v_sin_f32 v221, v217
    v_cvt_pk_bf16_f32 v216, v218, v219
    v_cvt_pk_bf16_f32 v217, v220, v221
    v_accvgpr_write_b32 a177, v216
    v_accvgpr_write_b32 a185, v217
    v_xor_b32 v217, 0x80008000, v217
    v_accvgpr_write_b32 a193, v217
    v_fmamk_f32 v210, v207, 0x41800000, v208
    v_fmamk_f32 v211, v207, 0x41880000, v208
    v_cos_f32 v212, v210
    v_cos_f32 v213, v211
    v_sin_f32 v214, v210
    v_sin_f32 v215, v211
    v_cvt_pk_bf16_f32 v210, v212, v213
    v_cvt_pk_bf16_f32 v211, v214, v215
    v_accvgpr_write_b32 a178, v210
    v_accvgpr_write_b32 a186, v211
    v_xor_b32 v211, 0x80008000, v211
    v_accvgpr_write_b32 a194, v211
    v_fmamk_f32 v216, v207, 0x41900000, v208
    v_fmamk_f32 v217, v207, 0x41980000, v208
    v_cos_f32 v218, v216
    v_cos_f32 v219, v217
    v_sin_f32 v220, v216
    v_sin_f32 v221, v217
    v_cvt_pk_bf16_f32 v216, v218, v219
    v_cvt_pk_bf16_f32 v217, v220, v221
    v_accvgpr_write_b32 a179, v216
    v_accvgpr_write_b32 a187, v217
    v_xor_b32 v217, 0x80008000, v217
    v_accvgpr_write_b32 a195, v217
    v_add_f32 v207, 0x41800000, v204
    v_mul_f32 v207, 0x3d000000, v207
    v_mul_f32 v208, 4.0, v205
    v_mul_f32 v208, v208, v207
    v_fmamk_f32 v210, v207, 0x00000000, v208
    v_fmamk_f32 v211, v207, 0x3f800000, v208
    v_cos_f32 v212, v210
    v_cos_f32 v213, v211
    v_sin_f32 v214, v210
    v_sin_f32 v215, v211
    v_cvt_pk_bf16_f32 v210, v212, v213
    v_cvt_pk_bf16_f32 v211, v214, v215
    v_accvgpr_write_b32 a180, v210
    v_accvgpr_write_b32 a188, v211
    v_xor_b32 v211, 0x80008000, v211
    v_accvgpr_write_b32 a196, v211
    v_fmamk_f32 v216, v207, 0x40000000, v208
    v_fmamk_f32 v217, v207, 0x40400000, v208
    v_cos_f32 v218, v216
    v_cos_f32 v219, v217
    v_sin_f32 v220, v216
    v_sin_f32 v221, v217
    v_cvt_pk_bf16_f32 v216, v218, v219
    v_cvt_pk_bf16_f32 v217, v220, v221
    v_accvgpr_write_b32 a181, v216
    v_accvgpr_write_b32 a189, v217
    v_xor_b32 v217, 0x80008000, v217
    v_accvgpr_write_b32 a197, v217
    v_fmamk_f32 v210, v207, 0x41800000, v208
    v_fmamk_f32 v211, v207, 0x41880000, v208
    v_cos_f32 v212, v210
    v_cos_f32 v213, v211
    v_sin_f32 v214, v210
    v_sin_f32 v215, v211
    v_cvt_pk_bf16_f32 v210, v212, v213
    v_cvt_pk_bf16_f32 v211, v214, v215
    v_accvgpr_write_b32 a182, v210
    v_accvgpr_write_b32 a190, v211
    v_xor_b32 v211, 0x80008000, v211
    v_accvgpr_write_b32 a198, v211
    v_fmamk_f32 v216, v207, 0x41900000, v208
    v_fmamk_f32 v217, v207, 0x41980000, v208
    v_cos_f32 v218, v216
    v_cos_f32 v219, v217
    v_sin_f32 v220, v216
    v_sin_f32 v221, v217
    v_cvt_pk_bf16_f32 v216, v218, v219
    v_cvt_pk_bf16_f32 v217, v220, v221
    v_accvgpr_write_b32 a183, v216
    v_accvgpr_write_b32 a191, v217
    v_xor_b32 v217, 0x80008000, v217
    v_accvgpr_write_b32 a199, v217
    v_add_f32 v207, v206, v204
    v_mul_f32 v207, 0x3c800000, v207
    v_mul_f32 v208, 0x41000000, v205
    v_mul_f32 v208, v208, v207
    v_fmamk_f32 v210, v207, 0x00000000, v208
    v_fmamk_f32 v211, v207, 0x3f800000, v208
    v_cos_f32 v212, v210
    v_cos_f32 v213, v211
    v_sin_f32 v214, v210
    v_sin_f32 v215, v211
    v_cvt_pk_bf16_f32 v210, v212, v213
    v_cvt_pk_bf16_f32 v211, v214, v215
    v_accvgpr_write_b32 a200, v210
    v_accvgpr_write_b32 a208, v211
    v_xor_b32 v211, 0x80008000, v211
    v_accvgpr_write_b32 a216, v211
    v_fmamk_f32 v216, v207, 0x40000000, v208
    v_fmamk_f32 v217, v207, 0x40400000, v208
    v_cos_f32 v218, v216
    v_cos_f32 v219, v217
    v_sin_f32 v220, v216
    v_sin_f32 v221, v217
    v_cvt_pk_bf16_f32 v216, v218, v219
    v_cvt_pk_bf16_f32 v217, v220, v221
    v_accvgpr_write_b32 a201, v216
    v_accvgpr_write_b32 a209, v217
    v_xor_b32 v217, 0x80008000, v217
    v_accvgpr_write_b32 a217, v217
    v_fmamk_f32 v210, v207, 0x40800000, v208
    v_fmamk_f32 v211, v207, 0x40a00000, v208
    v_cos_f32 v212, v210
    v_cos_f32 v213, v211
    v_sin_f32 v214, v210
    v_sin_f32 v215, v211
    v_cvt_pk_bf16_f32 v210, v212, v213
    v_cvt_pk_bf16_f32 v211, v214, v215
    v_accvgpr_write_b32 a202, v210
    v_accvgpr_write_b32 a210, v211
    v_xor_b32 v211, 0x80008000, v211
    v_accvgpr_write_b32 a218, v211
    v_fmamk_f32 v216, v207, 0x40c00000, v208
    v_fmamk_f32 v217, v207, 0x40e00000, v208
    v_cos_f32 v218, v216
    v_cos_f32 v219, v217
    v_sin_f32 v220, v216
    s_add_u32 m0, s49, 33280
    v_sin_f32 v221, v217
    v_cvt_pk_bf16_f32 v216, v218, v219
    v_cvt_pk_bf16_f32 v217, v220, v221
    v_accvgpr_write_b32 a203, v216
    v_accvgpr_write_b32 a211, v217
    v_xor_b32 v217, 0x80008000, v217
    buffer_load_dwordx4 v8, s[8:11], s64 offen offset:0  lds
    v_accvgpr_write_b32 a219, v217
    v_fmamk_f32 v210, v207, 0x42000000, v208
    v_fmamk_f32 v211, v207, 0x42040000, v208
    v_cos_f32 v212, v210
    v_cos_f32 v213, v211
    v_sin_f32 v214, v210
    buffer_load_dwordx4 v9, s[8:11], s64 offen offset:1040  lds
    v_sin_f32 v215, v211
    v_cvt_pk_bf16_f32 v210, v212, v213
    v_cvt_pk_bf16_f32 v211, v214, v215
    v_accvgpr_write_b32 a204, v210
    v_accvgpr_write_b32 a212, v211
    v_xor_b32 v211, 0x80008000, v211
    buffer_load_dwordx4 v10, s[8:11], s64 offen offset:2080  lds
    v_accvgpr_write_b32 a220, v211
    v_fmamk_f32 v216, v207, 0x42080000, v208
    v_fmamk_f32 v217, v207, 0x420c0000, v208
    v_cos_f32 v218, v216
    v_cos_f32 v219, v217
    v_sin_f32 v220, v216
    buffer_load_dwordx4 v11, s[8:11], s64 offen offset:3120  lds
    v_sin_f32 v221, v217
    v_cvt_pk_bf16_f32 v216, v218, v219
    v_cvt_pk_bf16_f32 v217, v220, v221
    v_accvgpr_write_b32 a205, v216
    v_accvgpr_write_b32 a213, v217
    v_xor_b32 v217, 0x80008000, v217
    s_add_u32 m0, s49, 37440
    v_accvgpr_write_b32 a221, v217
    v_fmamk_f32 v210, v207, 0x42100000, v208
    v_fmamk_f32 v211, v207, 0x42140000, v208
    v_cos_f32 v212, v210
    v_cos_f32 v213, v211
    v_sin_f32 v214, v210
    v_sin_f32 v215, v211
    s_add_u32 s64, s64, 524288
    v_cvt_pk_bf16_f32 v210, v212, v213
    v_cvt_pk_bf16_f32 v211, v214, v215
    v_accvgpr_write_b32 a206, v210
    v_accvgpr_write_b32 a214, v211
    v_xor_b32 v211, 0x80008000, v211
    v_accvgpr_write_b32 a222, v211
    buffer_load_dwordx4 v8, s[8:11], s64 offen offset:0  lds
    v_fmamk_f32 v216, v207, 0x42180000, v208
    v_fmamk_f32 v217, v207, 0x421c0000, v208
    v_cos_f32 v218, v216
    v_cos_f32 v219, v217
    v_sin_f32 v220, v216
    v_sin_f32 v221, v217
    buffer_load_dwordx4 v9, s[8:11], s64 offen offset:1040  lds
    v_cvt_pk_bf16_f32 v216, v218, v219
    v_cvt_pk_bf16_f32 v217, v220, v221
    v_accvgpr_write_b32 a207, v216
    v_accvgpr_write_b32 a215, v217
    v_xor_b32 v217, 0x80008000, v217
    v_accvgpr_write_b32 a223, v217
    buffer_load_dwordx4 v10, s[8:11], s64 offen offset:2080  lds
    v_fma_f32 v209, v205, 4.0, v206
    v_add_f32 v207, 0x00000000, v204
    v_mul_f32 v207, 0x3a000000, v207
    v_mul_f32 v208, v207, v209
    v_fmamk_f32 v210, v207, 0x00000000, v208
    v_fmamk_f32 v211, v207, 0x3f800000, v208
    buffer_load_dwordx4 v11, s[8:11], s64 offen offset:3120  lds
    v_fmamk_f32 v212, v207, 0x40000000, v208
    v_fmamk_f32 v213, v207, 0x40400000, v208
    v_cos_f32 v214, v210
    v_cos_f32 v215, v211
    v_cos_f32 v216, v212
    v_cos_f32 v217, v213
    s_add_u32 s86, s46, 1
    v_sin_f32 v218, v210
    v_sin_f32 v219, v211
    v_sin_f32 v220, v212
    v_sin_f32 v221, v213
    v_accvgpr_write_b32 a224, v214
    v_accvgpr_write_b32 a225, v215
    v_accvgpr_write_b32 a226, v216
    s_and_b32 s86, s86, 7
    v_accvgpr_write_b32 a227, v217
    v_accvgpr_write_b32 a232, v218
    v_accvgpr_write_b32 a233, v219
    v_accvgpr_write_b32 a234, v220
    v_accvgpr_write_b32 a235, v221
    v_add_f32 v207, 0x41800000, v204
    s_mul_i32 s86, s86, 229376
    v_mul_f32 v207, 0x3a000000, v207
    v_mul_f32 v208, v207, v209
    v_fmamk_f32 v210, v207, 0x00000000, v208
    v_fmamk_f32 v211, v207, 0x3f800000, v208
    v_fmamk_f32 v212, v207, 0x40000000, v208
    v_fmamk_f32 v213, v207, 0x40400000, v208
    s_add_u32 s86, s86, s88
    v_cos_f32 v214, v210
    v_cos_f32 v215, v211
    v_cos_f32 v216, v212
    v_cos_f32 v217, v213
    v_sin_f32 v218, v210
    v_sin_f32 v219, v211
    s_add_u32 s87, s86, 28672
    v_sin_f32 v220, v212
    v_sin_f32 v221, v213
    v_accvgpr_write_b32 a228, v214
    v_accvgpr_write_b32 a229, v215
    v_accvgpr_write_b32 a230, v216
    v_accvgpr_write_b32 a231, v217
    s_add_u32 m0, s89, 16384
    v_accvgpr_write_b32 a236, v218
    v_accvgpr_write_b32 a237, v219
    v_accvgpr_write_b32 a238, v220
    v_accvgpr_write_b32 a239, v221
    v_add_f32 v207, v206, v204
    v_mul_f32 v207, 0x3a000000, v207
    buffer_load_dwordx4 v5, s[12:15], s86 offen  lds
    v_mul_f32 v208, 4.0, v205
    v_mul_f32 v208, v208, v207
    v_fmamk_f32 v210, v207, 0x00000000, v208
    v_fmamk_f32 v211, v207, 0x3f800000, v208
    v_fmamk_f32 v212, v207, 0x40000000, v208
    v_fmamk_f32 v213, v207, 0x40400000, v208
    v_cos_f32 v214, v210
    s_add_u32 m0, s89, 17408
    v_cos_f32 v215, v211
    v_cos_f32 v216, v212
    v_cos_f32 v217, v213
    v_and_b32 v3, 31, v1
    v_mul_u32_u24 v3, 1040, v3
    v_lshrrev_b32 v4, 5, v1
    buffer_load_dwordx4 v5, s[12:15], s87 offen  lds
    v_lshl_add_u32 v3, v4, 4, v3
    v_add_u32 v4, 66560, v3
    v_and_b32 v12, 1, v1
    s_lshl_b32 s56, s3, 1
    v_add_u32 v12, s56, v12
    v_bfe_u32 v13, v1, 3, 1
    s_add_u32 m0, s89, 24576
    v_lshlrev_b32 v13, 1, v13
    v_xor_b32 v12, v12, v13
    v_bfe_u32 v13, v1, 4, 1
    v_lshlrev_b32 v14, 2, v13
    v_xor_b32 v12, v12, v14
    v_lshlrev_b32 v12, 4, v12
    buffer_load_dwordx4 v6, s[16:19], s86 offen  lds
    v_lshl_add_u32 v12, v13, 13, v12
    v_bfe_u32 v13, v1, 1, 1
    v_lshl_add_u32 v12, v13, 3, v12
    v_bfe_u32 v13, v1, 2, 2
    v_lshl_add_u32 v12, v13, 7, v12
    v_lshrrev_b32 v13, 5, v1
    s_add_u32 m0, s89, 25600
    v_lshl_add_u32 v145, v13, 10, v12
    v_add_u32 v147, 99840, v145
    v_mov_b32 v148, 0x3f803f80
    v_mov_b32 v149, 0x3f803f80
    v_mov_b32 v150, 0x3f803f80
    v_mov_b32 v151, 0x3f803f80
    buffer_load_dwordx4 v6, s[16:19], s87 offen  lds
    s_waitcnt vmcnt(17)
    v_lshlrev_b32 v24, 16, v16
    v_and_b32 v25, 0xffff0000, v16
    v_lshlrev_b32 v26, 16, v17
    v_and_b32 v27, 0xffff0000, v17
    v_lshlrev_b32 v28, 16, v18
    v_and_b32 v29, 0xffff0000, v18
    v_lshlrev_b32 v30, 16, v19
    v_and_b32 v31, 0xffff0000, v19
    s_waitcnt vmcnt(16)
    v_lshlrev_b32 v32, 16, v20
    v_and_b32 v33, 0xffff0000, v20
    v_lshlrev_b32 v34, 16, v21
    v_and_b32 v35, 0xffff0000, v21
    v_lshlrev_b32 v36, 16, v22
    v_and_b32 v37, 0xffff0000, v22
    v_lshlrev_b32 v38, 16, v23
    v_and_b32 v39, 0xffff0000, v23
    v_add_f32 v16, v24, v25
    v_add_f32 v17, v32, v33
    v_add_f32 v16, v16, v26
    v_add_f32 v17, v17, v34
    v_add_f32 v16, v16, v27
    v_add_f32 v17, v17, v35
    v_add_f32 v16, v16, v28
    v_add_f32 v17, v17, v36
    v_add_f32 v16, v16, v29
    v_add_f32 v17, v17, v37
    v_add_f32 v16, v16, v30
    v_add_f32 v17, v17, v38
    v_add_f32 v16, v16, v31
    v_add_f32 v17, v17, v39
    s_nop 0
    v_add_f32_dpp v16, v16, v16 row_shr:1 row_mask:0xf bank_mask:0xf bound_ctrl:0
    v_add_f32_dpp v17, v17, v17 row_shr:1 row_mask:0xf bank_mask:0xf bound_ctrl:0
    s_nop 0
    v_add_f32_dpp v16, v16, v16 row_shr:2 row_mask:0xf bank_mask:0xf bound_ctrl:0
    v_add_f32_dpp v17, v17, v17 row_shr:2 row_mask:0xf bank_mask:0xf bound_ctrl:0
    s_nop 0
    v_add_f32_dpp v16, v16, v16 row_shr:4 row_mask:0xf bank_mask:0xf bound_ctrl:0
    v_add_f32_dpp v17, v17, v17 row_shr:4 row_mask:0xf bank_mask:0xf bound_ctrl:0
    s_nop 0
    v_add_f32_dpp v16, v16, v16 row_shr:8 row_mask:0xf bank_mask:0xf bound_ctrl:0
    v_add_f32_dpp v17, v17, v17 row_shr:8 row_mask:0xf bank_mask:0xf bound_ctrl:0
    s_nop 0
    v_add_f32_dpp v16, v16, v16 row_bcast:15 row_mask:0xa bank_mask:0xf
    v_add_f32_dpp v17, v17, v17 row_bcast:15 row_mask:0xa bank_mask:0xf
    s_nop 0
    v_add_f32_dpp v16, v16, v16 row_bcast:31 row_mask:0xc bank_mask:0xf
    v_add_f32_dpp v17, v17, v17 row_bcast:31 row_mask:0xc bank_mask:0xf
    v_readlane_b32 s56, v16, 63
    v_readlane_b32 s57, v17, 63
    s_nop 0
    v_mov_b32 v18, s56
    v_mul_f32 v18, 0xbb000000, v18
    v_mov_b32 v19, s57
    v_mul_f32 v19, 0xbb000000, v19
    v_add_f32 v24, v24, v18
    v_add_f32 v32, v32, v19
    v_add_f32 v25, v25, v18
    v_add_f32 v33, v33, v19
    v_add_f32 v26, v26, v18
    v_add_f32 v34, v34, v19
    v_add_f32 v27, v27, v18
    v_add_f32 v35, v35, v19
    v_add_f32 v28, v28, v18
    v_add_f32 v36, v36, v19
    v_add_f32 v29, v29, v18
    v_add_f32 v37, v37, v19
    v_add_f32 v30, v30, v18
    v_add_f32 v38, v38, v19
    v_add_f32 v31, v31, v18
    v_add_f32 v39, v39, v19
    v_mul_f32 v16, v24, v24
    v_mul_f32 v17, v32, v32
    v_fmac_f32 v16, v25, v25
    v_fmac_f32 v17, v33, v33
    v_fmac_f32 v16, v26, v26
    v_fmac_f32 v17, v34, v34
    v_fmac_f32 v16, v27, v27
    v_fmac_f32 v17, v35, v35
    v_fmac_f32 v16, v28, v28
    v_fmac_f32 v17, v36, v36
    v_fmac_f32 v16, v29, v29
    v_fmac_f32 v17, v37, v37
    v_fmac_f32 v16, v30, v30
    v_fmac_f32 v17, v38, v38
    v_fmac_f32 v16, v31, v31
    v_fmac_f32 v17, v39, v39
    s_nop 0
    v_add_f32_dpp v16, v16, v16 row_shr:1 row_mask:0xf bank_mask:0xf bound_ctrl:0
    v_add_f32_dpp v17, v17, v17 row_shr:1 row_mask:0xf bank_mask:0xf bound_ctrl:0
    s_nop 0
    v_add_f32_dpp v16, v16, v16 row_shr:2 row_mask:0xf bank_mask:0xf bound_ctrl:0
    v_add_f32_dpp v17, v17, v17 row_shr:2 row_mask:0xf bank_mask:0xf bound_ctrl:0
    s_nop 0
    v_add_f32_dpp v16, v16, v16 row_shr:4 row_mask:0xf bank_mask:0xf bound_ctrl:0
    v_add_f32_dpp v17, v17, v17 row_shr:4 row_mask:0xf bank_mask:0xf bound_ctrl:0
    s_nop 0
    v_add_f32_dpp v16, v16, v16 row_shr:8 row_mask:0xf bank_mask:0xf bound_ctrl:0
    v_add_f32_dpp v17, v17, v17 row_shr:8 row_mask:0xf bank_mask:0xf bound_ctrl:0
    s_nop 0
    v_add_f32_dpp v16, v16, v16 row_bcast:15 row_mask:0xa bank_mask:0xf
    v_add_f32_dpp v17, v17, v17 row_bcast:15 row_mask:0xa bank_mask:0xf
    s_nop 0
    v_add_f32_dpp v16, v16, v16 row_bcast:31 row_mask:0xc bank_mask:0xf
    v_add_f32_dpp v17, v17, v17 row_bcast:31 row_mask:0xc bank_mask:0xf
    v_readlane_b32 s56, v16, 63
    v_readlane_b32 s57, v17, 63
    s_nop 0
    v_mov_b32 v21, s56
    v_mov_b32 v22, s57
    v_cmp_eq_u32 vcc, 0, v1
    s_nop 1
    v_cndmask_b32 v20, v19, v18, vcc
    v_cndmask_b32 v21, v22, v21, vcc
    v_mov_b32 v23, 0x3727c5ac
    v_fmamk_f32 v21, v21, 0x3b000000, v23
    v_rsq_f32 v22, v21
    v_cvt_pk_bf16_f32 v24, v20, v20
    v_and_b32 v24, 0xffff0000, v24
    v_sub_f32 v25, v20, v24
    v_cvt_pk_bf16_f32 v20, v24, v25
    s_waitcnt lgkmcnt(0)
    s_mul_i32 s40, s40, 0x9E3779B1
    s_add_u32 s40, s40, 0x7F4A7C15
    v_mul_f32 v22, 0xc0135761, v22
    v_mov_b32 v23, s40
    s_lshl_b32 s56, s1, 7
    s_lshl_b32 s57, s3, 5
    s_add_u32 s56, s56, s57
    s_add_u32 s56, s56, 65536
    s_mov_b64 exec, 3
    buffer_store_dwordx4 v[20:23], v2, s[36:39], s56 offen sc1
    s_mov_b64 exec, -1
    s_add_u32 s86, s46, 2
    s_and_b32 s86, s86, 7
    s_mul_i32 s86, s86, 229376
    s_add_u32 s86, s86, s88
    s_add_u32 s87, s86, 28672
    s_add_u32 m0, s89, 133120
    s_nop 0
    buffer_load_dwordx4 v5, s[12:15], s86 offen  lds
    s_add_u32 m0, s89, 134144
    s_nop 0
    buffer_load_dwordx4 v5, s[12:15], s87 offen  lds
    s_add_u32 m0, s89, 141312
    s_nop 0
    buffer_load_dwordx4 v6, s[16:19], s86 offen  lds
    s_add_u32 m0, s89, 142336
    s_nop 0
    buffer_load_dwordx4 v6, s[16:19], s87 offen  lds
    s_add_u32 s86, s46, 3
    s_and_b32 s86, s86, 7
    s_mul_i32 s86, s86, 229376
    s_add_u32 s86, s86, s88
    s_add_u32 s87, s86, 28672
    s_add_u32 m0, s89, 99840
    s_nop 0
    buffer_load_dwordx4 v5, s[12:15], s86 offen  lds
    s_add_u32 m0, s89, 100864
    s_nop 0
    buffer_load_dwordx4 v5, s[12:15], s87 offen  lds
    s_add_u32 m0, s89, 108032
    s_nop 0
    buffer_load_dwordx4 v6, s[16:19], s86 offen  lds
    s_add_u32 m0, s89, 109056
    s_nop 0
    buffer_load_dwordx4 v6, s[16:19], s87 offen  lds
    s_lshr_b32 s58, s42, 3
    s_and_b32 s52, s42, 7
    s_mov_b32 s53, 0x1098badc
    s_mov_b32 s85, 0x765432
    s_cmp_eq_u32 s58, 1
    s_cselect_b32 s53, 0x3276dc54, s53
    s_cselect_b32 s85, 0x9810ba, s85
    s_cmp_eq_u32 s58, 2
    s_cselect_b32 s53, 0xdc769810, s53
    s_cselect_b32 s85, 0xba3254, s85
    s_cmp_eq_u32 s58, 3
    s_cselect_b32 s53, 0x7610ba32, s53
    s_cselect_b32 s85, 0xdc5498, s85
    s_and_b32 s58, s52, 3
    s_lshl_b32 s58, s58, 2
    s_and_b32 s59, s53, 0xffff
    s_mul_i32 s59, s59, 0x10001
    s_lshr_b32 s59, s59, s58
    s_and_b32 s56, s59, 0xffff
    s_lshr_b32 s59, s85, 8
    s_mul_i32 s59, s59, 0x10001
    s_lshr_b32 s59, s59, s58
    s_and_b32 s57, s59, 0xffff
    s_lshr_b32 s60, s53, 16
    s_and_b32 s59, s85, 0xff
    s_lshl_b32 s59, s59, 16
    s_or_b32 s60, s60, s59
    s_lshr_b32 s61, s60, 8
    s_lshl_b32 s59, s60, 24
    s_or_b32 s60, s60, s59
    s_mul_i32 s58, s52, 3
    s_and_b32 s58, s58, 28
    s_lshr_b64 s[60:61], s[60:61], s58
    s_lshl_b32 s53, s60, 16
    s_or_b32 s53, s53, s56
    s_bfe_u32 s85, s60, 524304
    s_lshl_b32 s57, s57, 8
    s_or_b32 s85, s85, s57
    s_add_u32 s86, s46, 4
    s_and_b32 s86, s86, 7
    s_mul_i32 s86, s86, 229376
    s_add_u32 s86, s86, s88
    s_add_u32 s87, s86, 28672
    s_add_u32 m0, s89, 116224
    s_nop 0
    buffer_load_dwordx4 v5, s[12:15], s86 offen  lds
    s_add_u32 m0, s89, 117248
    s_nop 0
    buffer_load_dwordx4 v5, s[12:15], s87 offen  lds
    s_add_u32 m0, s89, 124416
    s_nop 0
    buffer_load_dwordx4 v6, s[16:19], s86 offen  lds
    s_add_u32 m0, s89, 125440
    s_nop 0
    buffer_load_dwordx4 v6, s[16:19], s87 offen  lds
    s_waitcnt lgkmcnt(0)
    s_waitcnt vmcnt(17)
    s_barrier
    ds_read_b64_tr_b16 a[0:1], v145 offset:0
    ds_read_b64_tr_b16 a[2:3], v145 offset:512
    ds_read_b128 v[48:51], v3 offset:33280
    ds_read_b64_tr_b16 a[4:5], v145 offset:2048
    ds_read_b64_tr_b16 a[6:7], v145 offset:2560
    ds_read_b128 v[52:55], v3 offset:33312
    ds_read_b64_tr_b16 a[8:9], v145 offset:4096
    ds_read_b64_tr_b16 a[10:11], v145 offset:4608
    ds_read_b128 v[56:59], v3 offset:33344
    ds_read_b64_tr_b16 a[12:13], v145 offset:6144
    ds_read_b64_tr_b16 a[14:15], v145 offset:6656
    ds_read_b128 v[60:63], v3 offset:33376
    s_waitcnt lgkmcnt(0)
    s_waitcnt vmcnt(13)
    s_barrier
    v_mfma_f32_32x32x16_bf16 v[16:31], a[0:3], v[48:51], 0
    ds_read_b64_tr_b16 a[16:17], v145 offset:16384
    ds_read_b64_tr_b16 a[18:19], v145 offset:16896
    s_add_u32 s86, s46, 5
    s_and_b32 s86, s86, 7
    s_mul_i32 s86, s86, 229376
    s_add_u32 s86, s86, s88
    s_add_u32 s87, s86, 28672
    s_add_u32 m0, s89, 0
    s_nop 0
    buffer_load_dwordx4 v5, s[12:15], s86 offen  lds
    v_mfma_f32_32x32x16_bf16 v[152:167], v[148:151], a[0:3], 0
    ds_read_b128 v[64:67], v3 offset:33408
    ds_read_b64_tr_b16 a[20:21], v145 offset:18432
    s_add_u32 m0, s89, 1024
    s_nop 0
    buffer_load_dwordx4 v5, s[12:15], s87 offen  lds
    s_lshl_b32 s59, s44, 3
    s_mul_i32 s50, s59, 112
    s_lshl_b32 s59, s43, 2
    v_mfma_f32_32x32x16_bf16 v[16:31], a[4:7], v[52:55], v[16:31]
    ds_read_b64_tr_b16 a[22:23], v145 offset:18944
    ds_read_b128 v[68:71], v3 offset:33440
    s_add_u32 m0, s89, 8192
    s_nop 0
    buffer_load_dwordx4 v6, s[16:19], s86 offen  lds
    s_add_u32 s50, s50, s59
    s_add_u32 s50, s50, s3
    s_lshl_b32 s50, s50, 10
    s_add_u32 s50, s50, 7340032
    v_mfma_f32_32x32x16_bf16 v[152:167], v[148:151], a[4:7], v[152:167]
    ds_read_b64_tr_b16 a[24:25], v145 offset:20480
    ds_read_b64_tr_b16 a[26:27], v145 offset:20992
    s_add_u32 m0, s89, 9216
    s_nop 0
    buffer_load_dwordx4 v6, s[16:19], s87 offen  lds
    s_bfe_u32 s58, s45, 262144
    s_mul_i32 s72, s58, 114688
    s_add_u32 s72, s72, s50
    s_bfe_u32 s58, s45, 262148
    v_mfma_f32_32x32x16_bf16 v[16:31], a[8:11], v[56:59], v[16:31]
    ds_read_b128 v[72:75], v3 offset:33472
    ds_read_b64_tr_b16 a[28:29], v145 offset:22528
    s_add_u32 m0, s49, 66560
    s_nop 0
    buffer_load_dwordx4 v8, s[8:11], s65 offen offset:0  lds
    s_mul_i32 s73, s58, 114688
    s_add_u32 s73, s73, s50
    s_bfe_u32 s58, s45, 262152
    s_lshl_b32 s66, s58, 10
    v_mfma_f32_32x32x16_bf16 v[152:167], v[148:151], a[8:11], v[152:167]
    ds_read_b64_tr_b16 a[30:31], v145 offset:23040
    ds_read_b128 v[76:79], v3 offset:33504
    buffer_load_dwordx4 v9, s[8:11], s65 offen offset:1040  lds
    s_add_u32 s66, s66, s48
    s_mul_i32 s74, s58, 114688
    s_add_u32 s74, s74, s50
    s_bfe_u32 s58, s45, 262156
    v_mfma_f32_32x32x16_bf16 v[16:31], a[12:15], v[60:63], v[16:31]
    buffer_load_dwordx4 v10, s[8:11], s65 offen offset:2080  lds
    s_lshl_b32 s67, s58, 10
    s_add_u32 s67, s67, s48
    s_mul_i32 s75, s58, 114688
    s_add_u32 s75, s75, s50
    s_bfe_u32 s58, s45, 262160
    s_lshl_b32 s68, s58, 10
    s_add_u32 s68, s68, s48
    s_mul_i32 s76, s58, 114688
    s_add_u32 s76, s76, s50
    s_bfe_u32 s58, s45, 262164
    v_mfma_f32_32x32x16_bf16 v[152:167], v[148:151], a[12:15], v[152:167]
    buffer_load_dwordx4 v11, s[8:11], s65 offen offset:3120  lds
    s_waitcnt lgkmcnt(0)
    s_waitcnt vmcnt(16)
    s_barrier
    v_mfma_f32_32x32x16_bf16 v[16:31], a[16:19], v[64:67], v[16:31]
    ds_read_b64_tr_b16 a[32:33], v147 offset:33280
    ds_read_b64_tr_b16 a[34:35], v147 offset:33792
    s_add_u32 s86, s46, 6
    s_and_b32 s86, s86, 7
    s_mul_i32 s86, s86, 229376
    s_add_u32 s86, s86, s88
    s_add_u32 s87, s86, 28672
    s_add_u32 m0, s89, 16384
    s_nop 0
    buffer_load_dwordx4 v5, s[12:15], s86 offen  lds
    v_mfma_f32_32x32x16_bf16 v[152:167], v[148:151], a[16:19], v[152:167]
    ds_read_b128 v[80:83], v3 offset:33536
    ds_read_b64_tr_b16 a[36:37], v147 offset:35328
    s_add_u32 m0, s89, 17408
    s_nop 0
    buffer_load_dwordx4 v5, s[12:15], s87 offen  lds
    s_lshl_b32 s69, s58, 10
    s_add_u32 s69, s69, s48
    s_mul_i32 s77, s58, 114688
    v_mfma_f32_32x32x16_bf16 v[16:31], a[20:23], v[68:71], v[16:31]
    ds_read_b64_tr_b16 a[38:39], v147 offset:35840
    ds_read_b128 v[84:87], v3 offset:33568
    s_add_u32 m0, s89, 24576
    s_nop 0
    buffer_load_dwordx4 v6, s[16:19], s86 offen  lds
    s_add_u32 s77, s77, s50
    s_bfe_u32 s58, s45, 262168
    s_lshl_b32 s70, s58, 10
    s_add_u32 s70, s70, s48
    v_mfma_f32_32x32x16_bf16 v[152:167], v[148:151], a[20:23], v[152:167]
    ds_read_b64_tr_b16 a[40:41], v147 offset:37376
    ds_read_b64_tr_b16 a[42:43], v147 offset:37888
    s_add_u32 m0, s89, 25600
    s_nop 0
    buffer_load_dwordx4 v6, s[16:19], s87 offen  lds
    s_mul_i32 s78, s58, 114688
    s_add_u32 s78, s78, s50
    s_bfe_u32 s58, s45, 262172
    s_lshl_b32 s71, s58, 10
    v_mfma_f32_32x32x16_bf16 v[16:31], a[24:27], v[72:75], v[16:31]
    ds_read_b128 v[88:91], v3 offset:33600
    ds_read_b64_tr_b16 a[44:45], v147 offset:39424
    s_add_u32 m0, s49, 70720
    s_add_u32 s65, s65, 524288
    buffer_load_dwordx4 v8, s[8:11], s65 offen offset:0  lds
    s_add_u32 s71, s71, s48
    s_mul_i32 s79, s58, 114688
    v_mfma_f32_32x32x16_bf16 v[152:167], v[148:151], a[24:27], v[152:167]
    ds_read_b64_tr_b16 a[46:47], v147 offset:39936
    ds_read_b128 v[92:95], v3 offset:33632
    buffer_load_dwordx4 v9, s[8:11], s65 offen offset:1040  lds
    s_add_u32 s79, s79, s50
    s_lshl_b32 s58, s44, 5
    s_add_u32 s58, s58, s43
    s_lshl_b32 s58, s58, 7
    s_add_u32 s50, s58, 655360
    v_mfma_f32_32x32x16_bf16 v[16:31], a[28:31], v[76:79], v[16:31]
    buffer_load_dwordx4 v10, s[8:11], s65 offen offset:2080  lds
    s_mul_i32 s58, s3, 98304
    s_add_u32 s50, s50, s58
    v_and_b32 v12, 31, v1
    v_lshlrev_b32 v12, 4, v12
    v_sin_f32 v218, v210
    v_mfma_f32_32x32x16_bf16 v[152:167], v[148:151], a[28:31], v[152:167]
    buffer_load_dwordx4 v11, s[8:11], s65 offen offset:3120  lds
    s_waitcnt lgkmcnt(0)
    s_waitcnt vmcnt(20)
    s_barrier
    v_mfma_f32_32x32x16_bf16 v[16:31], a[32:35], v[80:83], v[16:31]
    ds_read_b64_tr_b16 a[48:49], v147 offset:0
    ds_read_b64_tr_b16 a[50:51], v147 offset:512
    s_add_u32 s86, s46, 7
    s_and_b32 s86, s86, 7
    s_mul_i32 s86, s86, 229376
    s_add_u32 s86, s86, s88
    s_add_u32 s87, s86, 28672
    s_add_u32 m0, s89, 133120
    s_nop 0
    buffer_load_dwordx4 v5, s[12:15], s86 offen  lds
    v_mfma_f32_32x32x16_bf16 v[152:167], v[148:151], a[32:35], v[152:167]
    ds_read_b128 v[48:51], v3 offset:33664
    ds_read_b64_tr_b16 a[52:53], v147 offset:2048
    v_sin_f32 v219, v211
    v_sin_f32 v220, v212
    v_mfma_f32_32x32x16_bf16 v[16:31], a[36:39], v[84:87], v[16:31]
    ds_read_b64_tr_b16 a[54:55], v147 offset:2560
    ds_read_b128 v[52:55], v3 offset:33696
    s_add_u32 m0, s89, 134144
    s_nop 0
    buffer_load_dwordx4 v5, s[12:15], s87 offen  lds
    v_sin_f32 v221, v213
    v_mul_f32 v214, s0, v214
    v_mfma_f32_32x32x16_bf16 v[152:167], v[148:151], a[36:39], v[152:167]
    ds_read_b64_tr_b16 a[56:57], v147 offset:4096
    ds_read_b64_tr_b16 a[58:59], v147 offset:4608
    v_mul_f32 v215, s0, v215
    v_mul_f32 v216, s0, v216
    v_mul_f32 v217, s0, v217
    v_mul_f32 v218, s0, v218
    v_mul_f32 v219, s0, v219
    v_mfma_f32_32x32x16_bf16 v[16:31], a[40:43], v[88:91], v[16:31]
    ds_read_b128 v[56:59], v3 offset:33728
    ds_read_b64_tr_b16 a[60:61], v147 offset:6144
    s_add_u32 m0, s89, 141312
    s_nop 0
    buffer_load_dwordx4 v6, s[16:19], s86 offen  lds
    v_mul_f32 v220, s0, v220
    v_mul_f32 v221, s0, v221
    v_mfma_f32_32x32x16_bf16 v[152:167], v[148:151], a[40:43], v[152:167]
    ds_read_b64_tr_b16 a[62:63], v147 offset:6656
    ds_read_b128 v[60:63], v3 offset:33760
    v_accvgpr_write_b32 a240, v214
    v_accvgpr_write_b32 a241, v215
    v_accvgpr_write_b32 a242, v216
    v_accvgpr_write_b32 a243, v217
    v_accvgpr_write_b32 a248, v218
    v_mfma_f32_32x32x16_bf16 v[16:31], a[44:47], v[92:95], v[16:31]
    s_add_u32 m0, s89, 142336
    s_nop 0
    buffer_load_dwordx4 v6, s[16:19], s87 offen  lds
    v_accvgpr_write_b32 a249, v219
    v_accvgpr_write_b32 a250, v220
    v_accvgpr_write_b32 a251, v221
    v_fmamk_f32 v210, v207, 0x41800000, v208
    v_fmamk_f32 v211, v207, 0x41880000, v208
    v_mfma_f32_32x32x16_bf16 v[152:167], v[148:151], a[44:47], v[152:167]
    v_fmamk_f32 v212, v207, 0x41900000, v208
    v_fmamk_f32 v213, v207, 0x41980000, v208
    s_waitcnt lgkmcnt(0)
    s_waitcnt vmcnt(20)
    s_barrier
    v_mfma_f32_32x32x16_bf16 v[16:31], a[48:51], v[48:51], v[16:31]
    ds_read_b64_tr_b16 a[64:65], v147 offset:16384
    ds_read_b64_tr_b16 a[66:67], v147 offset:16896
    s_lshr_b32 s56, s64, 1
    s_and_b32 s56, s56, 0x7e00
    s_add_u32 s56, s56, 65536
    buffer_load_dwordx4 v[96:99], v12, s[36:39], s56 offen sc1
    v_cos_f32 v214, v210
    v_mfma_f32_32x32x16_bf16 v[152:167], v[148:151], a[48:51], v[152:167]
    ds_read_b128 v[64:67], v3 offset:33792
    ds_read_b64_tr_b16 a[68:69], v147 offset:18432
    s_lshr_b32 s56, s65, 1
    s_and_b32 s56, s56, 0x7e00
    s_add_u32 s56, s56, 65536
    buffer_load_dwordx4 v[100:103], v12, s[36:39], s56 offen sc1
    v_mfma_f32_32x32x16_bf16 v[16:31], a[52:55], v[52:55], v[16:31]
    ds_read_b64_tr_b16 a[70:71], v147 offset:18944
    ds_read_b128 v[68:71], v3 offset:33824
    s_lshr_b32 s56, s66, 1
    s_and_b32 s56, s56, 0x7e00
    s_add_u32 s56, s56, 65536
    buffer_load_dwordx4 v[104:107], v12, s[36:39], s56 offen sc1
    v_cos_f32 v215, v211
    v_mfma_f32_32x32x16_bf16 v[152:167], v[148:151], a[52:55], v[152:167]
    ds_read_b64_tr_b16 a[72:73], v147 offset:20480
    ds_read_b64_tr_b16 a[74:75], v147 offset:20992
    s_lshr_b32 s56, s67, 1
    s_and_b32 s56, s56, 0x7e00
    s_add_u32 s56, s56, 65536
    buffer_load_dwordx4 v[108:111], v12, s[36:39], s56 offen sc1
    v_mfma_f32_32x32x16_bf16 v[16:31], a[56:59], v[56:59], v[16:31]
    ds_read_b128 v[72:75], v3 offset:33856
    ds_read_b64_tr_b16 a[76:77], v147 offset:22528
    s_lshr_b32 s56, s68, 1
    s_and_b32 s56, s56, 0x7e00
    s_add_u32 s56, s56, 65536
    buffer_load_dwordx4 v[112:115], v12, s[36:39], s56 offen sc1
    v_cos_f32 v216, v212
    v_mfma_f32_32x32x16_bf16 v[152:167], v[148:151], a[56:59], v[152:167]
    ds_read_b64_tr_b16 a[78:79], v147 offset:23040
    ds_read_b128 v[76:79], v3 offset:33888
    s_lshr_b32 s56, s69, 1
    s_and_b32 s56, s56, 0x7e00
    s_add_u32 s56, s56, 65536
    buffer_load_dwordx4 v[116:119], v12, s[36:39], s56 offen sc1
    v_mfma_f32_32x32x16_bf16 v[16:31], a[60:63], v[60:63], v[16:31]
    s_lshr_b32 s56, s70, 1
    s_and_b32 s56, s56, 0x7e00
    s_add_u32 s56, s56, 65536
    buffer_load_dwordx4 v[120:123], v12, s[36:39], s56 offen sc1
    v_cos_f32 v217, v213
    v_sin_f32 v218, v210
    v_mfma_f32_32x32x16_bf16 v[152:167], v[148:151], a[60:63], v[152:167]
    s_lshr_b32 s56, s71, 1
    s_and_b32 s56, s56, 0x7e00
    s_add_u32 s56, s56, 65536
    buffer_load_dwordx4 v[124:127], v12, s[36:39], s56 offen sc1
    s_waitcnt lgkmcnt(0)
    s_waitcnt vmcnt(24)
    s_barrier
    v_mfma_f32_32x32x16_bf16 v[16:31], a[64:67], v[64:67], v[16:31]
    ds_read_b64_tr_b16 a[80:81], v145 offset:0
    ds_read_b64_tr_b16 a[82:83], v145 offset:512
    s_add_u32 m0, s49, 99840
    s_nop 0
    buffer_load_dwordx4 v8, s[8:11], s66 offen offset:0  lds
    v_sin_f32 v219, v211
    v_mfma_f32_32x32x16_bf16 v[152:167], v[148:151], a[64:67], v[152:167]
    ds_read_b128 v[80:83], v3 offset:33920
    ds_read_b64_tr_b16 a[84:85], v145 offset:2048
    buffer_load_dwordx4 v9, s[8:11], s66 offen offset:1040  lds
    v_sin_f32 v220, v212
    v_sin_f32 v221, v213
    v_mfma_f32_32x32x16_bf16 v[16:31], a[68:71], v[68:71], v[16:31]
    ds_read_b64_tr_b16 a[86:87], v145 offset:2560
    ds_read_b128 v[84:87], v3 offset:33952
    buffer_load_dwordx4 v10, s[8:11], s66 offen offset:2080  lds
    v_mul_f32 v214, s0, v214
    v_mul_f32 v215, s0, v215
    v_mfma_f32_32x32x16_bf16 v[152:167], v[148:151], a[68:71], v[152:167]
    ds_read_b64_tr_b16 a[88:89], v145 offset:4096
    ds_read_b64_tr_b16 a[90:91], v145 offset:4608
    buffer_load_dwordx4 v11, s[8:11], s66 offen offset:3120  lds
    v_mul_f32 v216, s0, v216
    v_mul_f32 v217, s0, v217
    v_mul_f32 v218, s0, v218
    v_mfma_f32_32x32x16_bf16 v[16:31], a[72:75], v[72:75], v[16:31]
    ds_read_b128 v[88:91], v3 offset:33984
    ds_read_b64_tr_b16 a[92:93], v145 offset:6144
    s_add_u32 m0, s49, 104000
    s_add_u32 s66, s66, 524288
    buffer_load_dwordx4 v8, s[8:11], s66 offen offset:0  lds
    v_mul_f32 v219, s0, v219
    v_mul_f32 v220, s0, v220
    v_mfma_f32_32x32x16_bf16 v[152:167], v[148:151], a[72:75], v[152:167]
    ds_read_b64_tr_b16 a[94:95], v145 offset:6656
    ds_read_b128 v[92:95], v3 offset:34016
    buffer_load_dwordx4 v9, s[8:11], s66 offen offset:1040  lds
    v_mul_f32 v221, s0, v221
    v_accvgpr_write_b32 a244, v214
    v_mfma_f32_32x32x16_bf16 v[16:31], a[76:79], v[76:79], v[16:31]
    buffer_load_dwordx4 v10, s[8:11], s66 offen offset:2080  lds
    v_accvgpr_write_b32 a245, v215
    v_accvgpr_write_b32 a246, v216
    v_accvgpr_write_b32 a247, v217
    v_accvgpr_write_b32 a252, v218
    v_accvgpr_write_b32 a253, v219
    v_accvgpr_write_b32 a254, v220
    v_mfma_f32_32x32x16_bf16 v[152:167], v[148:151], a[76:79], v[152:167]
    buffer_load_dwordx4 v11, s[8:11], s66 offen offset:3120  lds
    s_waitcnt lgkmcnt(0)
    s_waitcnt vmcnt(24)
    s_barrier
    v_mfma_f32_32x32x16_bf16 v[16:31], a[80:83], v[80:83], v[16:31]
    ds_read_b64_tr_b16 a[96:97], v145 offset:16384
    ds_read_b64_tr_b16 a[98:99], v145 offset:16896
    s_lshl_b32 s92, s43, 3
    s_add_u32 s92, s92, s44
    s_lshl_b32 s92, s92, 2
    s_add_u32 s92, s92, s3
    s_lshl_b32 s92, s92, 11
    v_and_b32 v190, 15, v1
    v_lshlrev_b32 v190, 7, v190
    buffer_load_dword v190, v190, s[20:23], s92 offen
    v_mfma_f32_32x32x16_bf16 v[152:167], v[148:151], a[80:83], v[152:167]
    ds_read_b128 v[48:51], v3 offset:34048
    ds_read_b64_tr_b16 a[100:101], v145 offset:18432
    v_accvgpr_write_b32 a255, v221
    s_lshl_b32 s58, s3, 10
    s_add_u32 s80, s58, 262144
    s_lshr_b32 s58, s1, 4
    s_lshl_b32 s58, s58, 13
    s_add_u32 s81, s58, 524288
    v_and_b32 v172, 7, v1
    v_mfma_f32_32x32x16_bf16 v[16:31], a[84:87], v[84:87], v[16:31]
    ds_read_b64_tr_b16 a[102:103], v145 offset:18944
    ds_read_b128 v[52:55], v3 offset:34080
    s_and_b32 s90, s2, 3
    s_lshl_b32 s90, s90, 7
    s_add_u32 s90, s90, 2
    v_lshl_add_u32 v191, v1, 1, s90
    s_and_b32 s91, s2, 0xfc
    s_add_u32 s91, s91, s3
    s_lshr_b32 s90, s91, 4
    s_lshl_b32 s90, s90, 7
    s_and_b32 s91, s91, 15
    s_add_u32 s90, s90, s91
    s_mul_i32 s90, s90, 514
    s_add_u32 s91, s90, 0
    buffer_load_ushort v240, v191, s[24:27], s91 offen nt
    v_mfma_f32_32x32x16_bf16 v[152:167], v[148:151], a[84:87], v[152:167]
    ds_read_b64_tr_b16 a[104:105], v145 offset:20480
    ds_read_b64_tr_b16 a[106:107], v145 offset:20992
    v_lshlrev_b32 v172, 7, v172
    v_lshrrev_b32 v173, 2, v0
    v_lshlrev_b32 v173, 7, v173
    v_and_b32 v184, 15, v1
    v_lshrrev_b32 v185, 4, v1
    v_mfma_f32_32x32x16_bf16 v[16:31], a[88:91], v[88:91], v[16:31]
    ds_read_b128 v[56:59], v3 offset:34112
    ds_read_b64_tr_b16 a[108:109], v145 offset:22528
    buffer_load_ushort v248, v191, s[28:31], s91 offen nt
    s_lshl_b32 s58, s3, 10
    v_lshl_add_u32 v168, v184, 6, s58
    v_lshl_add_u32 v168, v185, 4, v168
    v_mfma_f32_32x32x16_bf16 v[152:167], v[148:151], a[88:91], v[152:167]
    ds_read_b64_tr_b16 a[110:111], v145 offset:23040
    ds_read_b128 v[60:63], v3 offset:34144
    s_add_u32 s91, s90, 16448
    buffer_load_ushort v241, v191, s[24:27], s91 offen nt
    v_lshlrev_b32 v169, 5, v0
    v_and_b32 v186, 7, v184
    v_mfma_f32_32x32x16_bf16 v[16:31], a[92:95], v[92:95], v[16:31]
    v_lshlrev_b32 v184, 7, v184
    v_add_u32 v184, 147456, v184
    v_xor_b32 v171, v185, v186
    v_lshl_add_u32 v171, v171, 4, v184
    v_lshrrev_b32 v170, 1, v185
    s_lshl_b32 s58, s3, 1
    v_add_u32 v170, s58, v170
    v_xor_b32 v170, v170, v186
    v_mfma_f32_32x32x16_bf16 v[152:167], v[148:151], a[92:95], v[152:167]
    buffer_load_ushort v249, v191, s[28:31], s91 offen nt
    s_waitcnt lgkmcnt(0)
    s_waitcnt vmcnt(21)
    s_barrier
    v_mfma_f32_32x32x16_bf16 v[16:31], a[96:99], v[48:51], v[16:31]
    ds_read_b64_tr_b16 a[112:113], v147 offset:33280
    ds_read_b64_tr_b16 a[114:115], v147 offset:33792
    s_add_u32 s91, s90, 32896
    buffer_load_ushort v242, v191, s[24:27], s91 offen nt
    v_lshl_add_u32 v170, v170, 4, v184
    v_and_b32 v185, 1, v185
    v_lshl_add_u32 v170, v185, 3, v170
    v_mfma_f32_32x32x16_bf16 v[152:167], v[148:151], a[96:99], v[152:167]
    ds_read_b128 v[64:67], v3 offset:34176
    ds_read_b64_tr_b16 a[116:117], v147 offset:35328
    buffer_load_ushort v250, v191, s[28:31], s91 offen nt
    s_lshl_b32 s51, s41, 2
    s_lshr_b32 s58, s42, 3
    s_add_u32 s51, s51, s58
    s_lshl_b32 s51, s51, 1
    v_mfma_f32_32x32x16_bf16 v[16:31], a[100:103], v[52:55], v[16:31]
    ds_read_b64_tr_b16 a[118:119], v147 offset:35840
    ds_read_b128 v[68:71], v3 offset:34208
    s_lshl_b32 s82, s3, 12
    s_mul_i32 s83, s3, 458752
    v_lshrrev_b32 v184, 3, v1
    v_and_b32 v185, 7, v1
    v_and_b32 v186, 2, v184
    v_mfma_f32_32x32x16_bf16 v[152:167], v[148:151], a[100:103], v[152:167]
    ds_read_b64_tr_b16 a[120:121], v147 offset:37376
    ds_read_b64_tr_b16 a[122:123], v147 offset:37888
    s_add_u32 s91, s90, 49344
    buffer_load_ushort v243, v191, s[24:27], s91 offen nt
    v_lshlrev_b32 v186, 1, v186
    v_xor_b32 v185, v185, v186
    v_lshlrev_b32 v185, 4, v185
    v_mfma_f32_32x32x16_bf16 v[16:31], a[104:107], v[56:59], v[16:31]
    ds_read_b128 v[72:75], v3 offset:34240
    ds_read_b64_tr_b16 a[124:125], v147 offset:39424
    buffer_load_ushort v251, v191, s[28:31], s91 offen nt
    v_lshl_add_u32 v174, v184, 10, v185
    s_lshl_b32 s58, s52, 7
    v_add_u32 v174, s58, v174
    v_mfma_f32_32x32x16_bf16 v[152:167], v[148:151], a[104:107], v[152:167]
    ds_read_b64_tr_b16 a[126:127], v147 offset:39936
    ds_read_b128 v[76:79], v3 offset:34272
    v_add_u32 v175, 7168, v174
    v_add_u32 v176, 14336, v174
    v_add_u32 v177, 21504, v174
    v_and_b32 v184, 1, v1
    v_lshlrev_b32 v184, 2, v184
    v_mfma_f32_32x32x16_bf16 v[16:31], a[108:111], v[60:63], v[16:31]
    s_add_u32 s91, s90, 8224
    buffer_load_ushort v244, v191, s[24:27], s91 offen nt
    v_bfe_u32 v185, v1, 4, 1
    v_lshl_or_b32 v184, v185, 1, v184
    v_bfe_u32 v185, v1, 1, 1
    v_or_b32 v184, v184, v185
    v_lshlrev_b32 v184, 3, v184
    v_mfma_f32_32x32x16_bf16 v[152:167], v[148:151], a[108:111], v[152:167]
    buffer_load_ushort v252, v191, s[28:31], s91 offen nt
    s_waitcnt lgkmcnt(0)
    s_barrier
    v_mfma_f32_32x32x16_bf16 v[16:31], a[112:115], v[64:67], v[16:31]
    ds_read_b128 v[80:83], v4 offset:0
    s_add_u32 s91, s90, 24672
    buffer_load_ushort v245, v191, s[24:27], s91 offen nt
    v_bfe_u32 v185, v1, 3, 1
    v_lshl_or_b32 v184, v185, 6, v184
    v_bfe_u32 v185, v1, 2, 2
    v_mfma_f32_32x32x16_bf16 v[152:167], v[148:151], a[112:115], v[152:167]
    ds_read_b128 v[84:87], v4 offset:32
    ds_read_b128 v[88:91], v4 offset:64
    buffer_load_ushort v253, v191, s[28:31], s91 offen nt
    v_lshl_or_b32 v184, v185, 7, v184
    v_lshrrev_b32 v185, 5, v1
    v_mfma_f32_32x32x16_bf16 v[16:31], a[116:119], v[68:71], v[16:31]
    ds_read_b128 v[92:95], v4 offset:96
    v_lshl_or_b32 v184, v185, 10, v184
    s_and_b32 s58, s3, 1
    s_lshl_b32 s58, s58, 6
    v_xor_b32 v178, s58, v184
    v_xor_b32 v179, 64, v178
    s_lshl_b32 s58, s3, 12
    s_add_u32 s48, s58, 147456
    v_add_u32 v180, s48, v178
    v_mfma_f32_32x32x16_bf16 v[152:167], v[148:151], a[116:119], v[152:167]
    ds_read_b128 v[48:51], v4 offset:128
    s_add_u32 s91, s90, 41120
    buffer_load_ushort v246, v191, s[24:27], s91 offen nt
    v_add_u32 v181, s48, v179
    v_add_u32 v178, s82, v178
    v_add_u32 v179, s82, v179
    v_mfma_f32_32x32x16_bf16 v[16:31], a[120:123], v[72:75], v[16:31]
    ds_read_b128 v[52:55], v4 offset:160
    ds_read_b128 v[56:59], v4 offset:192
    buffer_load_ushort v254, v191, s[28:31], s91 offen nt
    v_mfma_f32_32x32x16_bf16 v[152:167], v[148:151], a[120:123], v[152:167]
    ds_read_b128 v[60:63], v4 offset:224
    v_mfma_f32_32x32x16_bf16 v[16:31], a[124:127], v[76:79], v[16:31]
    s_add_u32 s91, s90, 57568
    buffer_load_ushort v247, v191, s[24:27], s91 offen nt
    v_mfma_f32_32x32x16_bf16 v[152:167], v[148:151], a[124:127], v[152:167]
    buffer_load_ushort v255, v191, s[28:31], s91 offen nt
    s_waitcnt vmcnt(32)
    v_cmp_ne_u32 vcc, s40, v99
    s_waitcnt vmcnt(31)
    v_cmp_ne_u32 s[62:63], s40, v103
    s_nop 0
    s_or_b64 vcc, vcc, s[62:63]
    s_waitcnt vmcnt(30)
    v_cmp_ne_u32 s[62:63], s40, v107
    s_nop 0
    s_or_b64 vcc, vcc, s[62:63]
    s_waitcnt vmcnt(29)
    v_cmp_ne_u32 s[62:63], s40, v111
    s_nop 0
    s_or_b64 vcc, vcc, s[62:63]
    s_waitcnt vmcnt(28)
    v_cmp_ne_u32 s[62:63], s40, v115
    s_nop 0
    s_or_b64 vcc, vcc, s[62:63]
    s_waitcnt vmcnt(27)
    v_cmp_ne_u32 s[62:63], s40, v119
    s_nop 0
    s_or_b64 vcc, vcc, s[62:63]
    s_waitcnt vmcnt(26)
    v_cmp_ne_u32 s[62:63], s40, v123
    s_nop 0
    s_or_b64 vcc, vcc, s[62:63]
    s_waitcnt vmcnt(25)
    v_cmp_ne_u32 s[62:63], s40, v127
    s_nop 0
    s_or_b64 vcc, vcc, s[62:63]
    s_cmp_lg_u64 vcc, 0
    s_cbranch_scc1 L_slow0
L_back0:
    v_cmp_gt_u32 vcc, 32, v1
    s_nop 1
    v_cndmask_b32 v164, 0, v152, vcc
    v_cvt_pk_bf16_f32 v152, v164, v164
    v_mov_b32 v154, 0
    v_mov_b32 v155, 0
    v_and_b32 v165, 0xffff0000, v152
    v_sub_f32 v164, v164, v165
    v_cvt_pk_bf16_f32 v153, v164, v164
    v_mov_b32 v158, 0
    v_mov_b32 v159, 0
    v_mov_b32 v162, 0
    v_mov_b32 v163, 0
    v_mov_b32 v156, v96
    v_mov_b32 v157, v96
    v_mov_b32 v160, v100
    v_mov_b32 v161, v100
    v_mfma_f32_32x32x16_bf16 v[16:31], v[152:155], v[156:159], v[16:31]
    s_add_u32 s58, s1, 1
    s_and_b32 s58, s58, 127
    s_sub_u32 s59, 383, s1
    s_cmp_ge_u32 s1, 128
    s_cselect_b32 s44, s59, s58
    s_cselect_b32 s43, 0x80008000, 0
    v_mfma_f32_32x32x16_bf16 v[32:47], v[152:155], v[160:163], 0
    s_add_u32 m0, s49, 0
    s_nop 0
    buffer_load_dwordx4 v8, s[8:11], s67 offen offset:0  lds
    s_lshr_b32 s58, s51, 3
    s_lshl_b32 s58, s58, 5
    s_waitcnt lgkmcnt(4)
    v_mfma_f32_32x32x16_bf16 v[32:47], a[0:3], v[80:83], v[32:47]
    ds_read_b128 v[64:67], v4 offset:256
    s_mul_i32 s59, s3, 7
    v_mul_f32 v144, v98, v98
    v_mul_f32 v144, 0x3c0a3963, v144
    v_mul_f32 v128, v16, v16
    v_mul_f32 v129, v17, v17
    v_mul_f32 v130, v18, v18
    v_mfma_f32_32x32x16_bf16 v[32:47], a[4:7], v[84:87], v[32:47]
    ds_read_b128 v[68:71], v4 offset:288
    buffer_load_dwordx4 v9, s[8:11], s67 offen offset:1040  lds
    s_add_u32 s58, s58, s59
    s_lshl_b32 s58, s58, 7
    v_mul_f32 v131, v19, v19
    v_mul_f32 v132, v20, v20
    v_mfma_f32_32x32x16_bf16 v[32:47], a[8:11], v[88:91], v[32:47]
    ds_read_b128 v[72:75], v4 offset:320
    s_add_u32 s46, s58, 655360
    s_mul_i32 s59, s3, 28
    v_mul_f32 v133, v21, v21
    v_mul_f32 v134, v22, v22
    v_mul_f32 v135, v23, v23
    v_mul_f32 v144, v144, v98
    v_mfma_f32_32x32x16_bf16 v[32:47], a[12:15], v[92:95], v[32:47]
    ds_read_b128 v[76:79], v4 offset:352
    v_min_u32 v187, 6, v1
    v_fma_f32 v128, v144, v128, v98
    v_fma_f32 v129, v144, v129, v98
    v_fma_f32 v130, v144, v130, v98
    s_waitcnt lgkmcnt(4)
    v_mfma_f32_32x32x16_bf16 v[32:47], a[16:19], v[48:51], v[32:47]
    ds_read_b128 v[80:83], v4 offset:384
    buffer_load_dwordx4 v10, s[8:11], s67 offen offset:2080  lds
    v_lshlrev_b32 v187, 7, v187
    s_lshr_b32 s58, s3, 1
    v_fma_f32 v131, v144, v131, v98
    v_mfma_f32_32x32x16_bf16 v[32:47], a[20:23], v[52:55], v[32:47]
    ds_read_b128 v[84:87], v4 offset:416
    s_add_u32 s45, s51, s58
    s_xor_b32 s58, s58, 1
    v_fma_f32 v132, v144, v132, v98
    v_fma_f32 v133, v144, v133, v98
    v_fma_f32 v134, v144, v134, v98
    v_fma_f32 v135, v144, v135, v98
    v_mfma_f32_32x32x16_bf16 v[32:47], a[24:27], v[56:59], v[32:47]
    ds_read_b128 v[88:91], v4 offset:448
    buffer_load_dwordx4 v11, s[8:11], s67 offen offset:3120  lds
    s_add_u32 s87, s51, s58
    v_mul_f32 v128, v16, v128
    v_mul_f32 v129, v17, v129
    v_mul_f32 v130, v18, v130
    v_mfma_f32_32x32x16_bf16 v[32:47], a[28:31], v[60:63], v[32:47]
    ds_read_b128 v[92:95], v4 offset:480
    s_mul_i32 s86, s45, 112
    s_add_u32 s86, s86, s59
    v_mul_f32 v131, v19, v131
    v_mul_f32 v132, v20, v132
    v_mul_f32 v133, v21, v133
    s_waitcnt lgkmcnt(4)
    v_mfma_f32_32x32x16_bf16 v[32:47], a[32:35], v[64:67], v[32:47]
    ds_read_b128 v[48:51], v4 offset:512
    s_lshl_b32 s86, s86, 10
    s_add_u32 s86, s86, 7340032
    v_mul_f32 v134, v22, v134
    v_mul_f32 v135, v23, v135
    v_exp_f32 v128, v128
    v_mfma_f32_32x32x16_bf16 v[32:47], a[36:39], v[68:71], v[32:47]
    ds_read_b128 v[52:55], v4 offset:544
    s_add_u32 m0, s49, 4160
    s_add_u32 s67, s67, 524288
    buffer_load_dwordx4 v8, s[8:11], s67 offen offset:0  lds
    s_mul_i32 s87, s87, 112
    v_mul_f32 v24, v16, v24
    v_mfma_f32_32x32x16_bf16 v[32:47], a[40:43], v[72:75], v[32:47]
    ds_read_b128 v[56:59], v4 offset:576
    s_add_u32 s87, s87, s59
    s_lshl_b32 s87, s87, 10
    v_exp_f32 v129, v129
    v_mul_f32 v25, v17, v25
    v_exp_f32 v130, v130
    v_mfma_f32_32x32x16_bf16 v[32:47], a[44:47], v[76:79], v[32:47]
    ds_read_b128 v[60:63], v4 offset:608
    buffer_load_dwordx4 v9, s[8:11], s67 offen offset:1040  lds
    s_add_u32 s87, s87, 7340032
    s_lshl_b32 s45, s45, 10
    v_mul_f32 v26, v18, v26
    s_waitcnt lgkmcnt(4)
    v_mfma_f32_32x32x16_bf16 v[32:47], a[48:51], v[80:83], v[32:47]
    ds_read_b128 v[64:67], v4 offset:640
    s_lshl_b32 s58, s52, 7
    v_exp_f32 v131, v131
    v_mul_f32 v27, v19, v27
    v_exp_f32 v132, v132
    v_mfma_f32_32x32x16_bf16 v[32:47], a[52:55], v[84:87], v[32:47]
    ds_read_b128 v[68:71], v4 offset:672
    s_add_u32 s45, s45, s58
    s_and_b32 s58, s3, 1
    v_mul_f32 v28, v20, v28
    v_exp_f32 v133, v133
    v_mfma_f32_32x32x16_bf16 v[32:47], a[56:59], v[88:91], v[32:47]
    ds_read_b128 v[72:75], v4 offset:704
    buffer_load_dwordx4 v10, s[8:11], s67 offen offset:2080  lds
    s_lshl_b32 s58, s58, 6
    s_add_u32 s45, s45, s58
    v_mul_f32 v29, v21, v29
    v_exp_f32 v134, v134
    v_mfma_f32_32x32x16_bf16 v[32:47], a[60:63], v[92:95], v[32:47]
    ds_read_b128 v[76:79], v4 offset:736
    v_and_b32 v188, 3, v1
    v_mov_b32 v156, v104
    v_mov_b32 v157, v104
    s_waitcnt lgkmcnt(4)
    v_mfma_f32_32x32x16_bf16 v[32:47], a[64:67], v[48:51], v[32:47]
    ds_read_b128 v[80:83], v4 offset:768
    buffer_load_dwordx4 v11, s[8:11], s67 offen offset:3120  lds
    v_bfe_u32 v189, v1, 3, 1
    v_lshl_or_b32 v188, v189, 2, v188
    v_mul_f32 v30, v22, v30
    v_mfma_f32_32x32x16_bf16 v[32:47], a[68:71], v[52:55], v[32:47]
    ds_read_b128 v[84:87], v4 offset:800
    v_bfe_u32 v189, v1, 4, 1
    v_lshl_or_b32 v188, v189, 3, v188
    v_exp_f32 v135, v135
    v_mul_f32 v31, v23, v31
    v_fma_f32 v128, v128, v97, v97
    v_mfma_f32_32x32x16_bf16 v[32:47], a[72:75], v[56:59], v[32:47]
    ds_read_b128 v[88:91], v4 offset:832
    v_bfe_u32 v189, v1, 2, 1
    v_fma_f32 v129, v129, v97, v97
    v_rcp_f32 v128, v128
    v_fma_f32 v130, v130, v97, v97
    v_mfma_f32_32x32x16_bf16 v[32:47], a[76:79], v[60:63], v[32:47]
    ds_read_b128 v[92:95], v4 offset:864
    s_waitcnt vmcnt(25)
    s_barrier
    v_lshl_or_b32 v188, v189, 4, v188
    s_lshl_b32 s58, s52, 6
    s_waitcnt lgkmcnt(4)
    v_mfma_f32_32x32x16_bf16 v[32:47], a[80:83], v[64:67], v[32:47]
    ds_read_b128 v[48:51], v4 offset:896
    s_and_b32 s59, s3, 1
    s_lshl_b32 s59, s59, 5
    v_rcp_f32 v129, v129
    v_fma_f32 v131, v131, v97, v97
    v_rcp_f32 v130, v130
    v_mfma_f32_32x32x16_bf16 v[32:47], a[84:87], v[68:71], v[32:47]
    ds_read_b128 v[52:55], v4 offset:928
    s_add_u32 s58, s58, s59
    v_fma_f32 v132, v132, v97, v97
    v_rcp_f32 v131, v131
    v_fma_f32 v133, v133, v97, v97
    v_mfma_f32_32x32x16_bf16 v[32:47], a[88:91], v[72:75], v[32:47]
    ds_read_b128 v[56:59], v4 offset:960
    v_add_u32 v188, s58, v188
    v_cvt_f32_u32 v188, v188
    v_rcp_f32 v132, v132
    v_fma_f32 v134, v134, v97, v97
    v_mfma_f32_32x32x16_bf16 v[32:47], a[92:95], v[76:79], v[32:47]
    ds_read_b128 v[60:63], v4 offset:992
    v_mul_f32 v188, 0x3b000000, v188
    v_lshrrev_b32 v189, 5, v1
    v_rcp_f32 v133, v133
    s_waitcnt lgkmcnt(4)
    v_mfma_f32_32x32x16_bf16 v[32:47], a[96:99], v[80:83], v[32:47]
    ds_read_b128 v[64:67], v4 offset:33280
    v_lshlrev_b32 v189, 2, v189
    v_fma_f32 v135, v135, v97, v97
    v_rcp_f32 v134, v134
    v_rcp_f32 v135, v135
    v_mfma_f32_32x32x16_bf16 v[32:47], a[100:103], v[84:87], v[32:47]
    ds_read_b128 v[68:71], v4 offset:33312
    s_mov_b32 m0, s48
    s_bfe_u32 s84, s53, 262144
    s_lshl_b32 s84, s84, 15
    s_add_u32 s84, s84, s83
    buffer_load_dwordx4 v174, s[20:23], s84 offen offset:0 lds
    v_cvt_f32_u32 v189, v189
    v_mul_f32 v189, v189, v188
    v_mfma_f32_32x32x16_bf16 v[32:47], a[104:107], v[88:91], v[32:47]
    ds_read_b128 v[72:75], v4 offset:33344
    v_bfe_u32 v186, v1, 2, 2
    v_bfe_u32 v185, v1, 4, 2
    v_mul_f32 v128, v24, v128
    v_mul_f32 v129, v25, v129
    v_mul_f32 v130, v26, v130
    v_mfma_f32_32x32x16_bf16 v[32:47], a[108:111], v[92:95], v[32:47]
    ds_read_b128 v[76:79], v4 offset:33376
    buffer_load_dwordx4 v175, s[20:23], s84 offen offset:1024 lds
    v_lshl_or_b32 v186, v185, 3, v186
    v_mul_f32 v131, v27, v131
    s_waitcnt lgkmcnt(4)
    v_mfma_f32_32x32x16_bf16 v[32:47], a[112:115], v[48:51], v[32:47]
    ds_read_b128 v[80:83], v4 offset:33408
    v_lshlrev_b32 v186, 16, v186
    v_and_b32 v185, 3, v1
    v_mul_f32 v132, v28, v132
    v_mul_f32 v133, v29, v133
    v_mul_f32 v134, v30, v134
    v_mfma_f32_32x32x16_bf16 v[32:47], a[116:119], v[52:55], v[32:47]
    ds_read_b128 v[84:87], v4 offset:33440
    buffer_load_dwordx4 v176, s[20:23], s84 offen offset:2048 lds
    v_lshl_or_b32 v186, v185, 4, v186
    v_xor_b32 v184, 64, v171
    v_mul_f32 v135, v31, v135
    v_mfma_f32_32x32x16_bf16 v[32:47], a[120:123], v[56:59], v[32:47]
    ds_read_b128 v[88:91], v4 offset:33472
    v_add_u32 v166, 66560, v178
    v_cvt_pk_bf16_f32 v136, v128, v129
    v_cvt_pk_bf16_f32 v137, v130, v131
    v_cvt_pk_bf16_f32 v138, v132, v133
    v_cvt_pk_bf16_f32 v139, v134, v135
    v_mfma_f32_32x32x16_bf16 v[32:47], a[124:127], v[60:63], v[32:47]
    ds_read_b128 v[92:95], v4 offset:33504
    buffer_load_dwordx4 v177, s[20:23], s84 offen offset:3072 lds
    v_add_u32 v167, 66560, v179
    s_add_u32 s47, s45, 262144
    buffer_store_dwordx4 v[136:139], v2, s[36:39], s72 offen sc1
    v_mfma_f32_32x32x16_bf16 v[16:31], v[152:155], v[156:159], 0
    s_add_u32 m0, s49, 33280
    s_nop 0
    buffer_load_dwordx4 v8, s[8:11], s68 offen offset:0  lds
    s_waitcnt lgkmcnt(4)
    v_mfma_f32_32x32x16_bf16 v[16:31], a[0:3], v[64:67], v[16:31]
    ds_read_b128 v[48:51], v4 offset:33536
    v_mul_f32 v144, v102, v102
    v_mul_f32 v144, 0x3c0a3963, v144
    v_mul_f32 v128, v32, v32
    v_mul_f32 v129, v33, v33
    v_mul_f32 v130, v34, v34
    v_mfma_f32_32x32x16_bf16 v[16:31], a[4:7], v[68:71], v[16:31]
    ds_read_b128 v[52:55], v4 offset:33568
    buffer_load_dwordx4 v9, s[8:11], s68 offen offset:1040  lds
    v_mul_f32 v131, v35, v35
    v_mul_f32 v132, v36, v36
    v_mul_f32 v133, v37, v37
    v_mfma_f32_32x32x16_bf16 v[16:31], a[8:11], v[72:75], v[16:31]
    ds_read_b128 v[56:59], v4 offset:33600
    v_mul_f32 v134, v38, v38
    v_mul_f32 v135, v39, v39
    v_mul_f32 v144, v144, v102
    v_fma_f32 v128, v144, v128, v102
    v_mfma_f32_32x32x16_bf16 v[16:31], a[12:15], v[76:79], v[16:31]
    ds_read_b128 v[60:63], v4 offset:33632
    v_fma_f32 v129, v144, v129, v102
    v_fma_f32 v130, v144, v130, v102
    v_fma_f32 v131, v144, v131, v102
    v_fma_f32 v132, v144, v132, v102
    s_waitcnt lgkmcnt(4)
    v_mfma_f32_32x32x16_bf16 v[16:31], a[16:19], v[80:83], v[16:31]
    ds_read_b128 v[64:67], v4 offset:33664
    buffer_load_dwordx4 v10, s[8:11], s68 offen offset:2080  lds
    v_fma_f32 v133, v144, v133, v102
    v_fma_f32 v134, v144, v134, v102
    v_fma_f32 v135, v144, v135, v102
    v_mfma_f32_32x32x16_bf16 v[16:31], a[20:23], v[84:87], v[16:31]
    ds_read_b128 v[68:71], v4 offset:33696
    v_mul_f32 v128, v32, v128
    v_mul_f32 v129, v33, v129
    v_mul_f32 v130, v34, v130
    v_mul_f32 v131, v35, v131
    v_mul_f32 v132, v36, v132
    v_mfma_f32_32x32x16_bf16 v[16:31], a[24:27], v[88:91], v[16:31]
    ds_read_b128 v[72:75], v4 offset:33728
    buffer_load_dwordx4 v11, s[8:11], s68 offen offset:3120  lds
    v_mul_f32 v133, v37, v133
    v_mul_f32 v134, v38, v134
    v_mfma_f32_32x32x16_bf16 v[16:31], a[28:31], v[92:95], v[16:31]
    ds_read_b128 v[76:79], v4 offset:33760
    s_waitcnt vmcnt(30)
    v_lshl_or_b32 v240, v241, 16, v240
    v_mul_f32 v135, v39, v135
    v_exp_f32 v128, v128
    s_waitcnt lgkmcnt(4)
    v_mfma_f32_32x32x16_bf16 v[16:31], a[32:35], v[48:51], v[16:31]
    ds_read_b128 v[80:83], v4 offset:33792
    s_waitcnt vmcnt(26)
    v_lshl_or_b32 v241, v243, 16, v242
    s_waitcnt vmcnt(22)
    v_lshl_or_b32 v242, v245, 16, v244
    v_mul_f32 v40, v32, v40
    v_exp_f32 v129, v129
    v_mfma_f32_32x32x16_bf16 v[16:31], a[36:39], v[52:55], v[16:31]
    ds_read_b128 v[84:87], v4 offset:33824
    s_add_u32 m0, s49, 37440
    s_add_u32 s68, s68, 524288
    buffer_load_dwordx4 v8, s[8:11], s68 offen offset:0  lds
    s_waitcnt vmcnt(19)
    v_lshl_or_b32 v243, v247, 16, v246
    v_mul_f32 v41, v33, v41
    v_mfma_f32_32x32x16_bf16 v[16:31], a[40:43], v[56:59], v[16:31]
    ds_read_b128 v[88:91], v4 offset:33856
    v_lshl_or_b32 v244, v249, 16, v248
    v_lshl_or_b32 v245, v251, 16, v250
    v_exp_f32 v130, v130
    v_mfma_f32_32x32x16_bf16 v[16:31], a[44:47], v[60:63], v[16:31]
    ds_read_b128 v[92:95], v4 offset:33888
    buffer_load_dwordx4 v9, s[8:11], s68 offen offset:1040  lds
    v_lshl_or_b32 v246, v253, 16, v252
    v_mul_f32 v42, v34, v42
    s_waitcnt lgkmcnt(4)
    v_mfma_f32_32x32x16_bf16 v[16:31], a[48:51], v[64:67], v[16:31]
    ds_read_b128 v[48:51], v4 offset:33920
    s_waitcnt vmcnt(19)
    v_lshl_or_b32 v247, v255, 16, v254
    v_exp_f32 v131, v131
    v_mul_f32 v43, v35, v43
    v_mfma_f32_32x32x16_bf16 v[16:31], a[52:55], v[68:71], v[16:31]
    ds_read_b128 v[52:55], v4 offset:33952
    s_lshl_b32 s90, s3, 5
    s_add_u32 s90, s90, 134144
    v_exp_f32 v132, v132
    v_mul_f32 v44, v36, v44
    v_exp_f32 v133, v133
    v_mfma_f32_32x32x16_bf16 v[16:31], a[56:59], v[72:75], v[16:31]
    ds_read_b128 v[56:59], v4 offset:33984
    buffer_load_dwordx4 v10, s[8:11], s68 offen offset:2080  lds
    v_mov_b32 v248, 144
    v_mul_f32 v45, v37, v45
    v_mfma_f32_32x32x16_bf16 v[16:31], a[60:63], v[76:79], v[16:31]
    ds_read_b128 v[60:63], v4 offset:34016
    v_mad_u32_u24 v191, v1, v248, s90
    ds_write_b128 v191, v[240:243]
    v_exp_f32 v134, v134
    s_waitcnt lgkmcnt(5)
    v_mfma_f32_32x32x16_bf16 v[16:31], a[64:67], v[80:83], v[16:31]
    ds_read_b128 v[64:67], v4 offset:34048
    buffer_load_dwordx4 v11, s[8:11], s68 offen offset:3120  lds
    ds_write_b128 v191, v[244:247] offset:16
    v_mfma_f32_32x32x16_bf16 v[16:31], a[68:71], v[84:87], v[16:31]
    ds_read_b128 v[68:71], v4 offset:34080
    v_mov_b32 v160, v108
    v_mov_b32 v161, v108
    v_mul_f32 v46, v38, v46
    v_exp_f32 v135, v135
    v_mfma_f32_32x32x16_bf16 v[16:31], a[72:75], v[88:91], v[16:31]
    ds_read_b128 v[72:75], v4 offset:34112
    v_mul_f32 v47, v39, v47
    v_fma_f32 v128, v128, v101, v101
    v_fma_f32 v129, v129, v101, v101
    v_rcp_f32 v128, v128
    v_mfma_f32_32x32x16_bf16 v[16:31], a[76:79], v[92:95], v[16:31]
    ds_read_b128 v[76:79], v4 offset:34144
    s_waitcnt lgkmcnt(3)
    s_waitcnt vmcnt(13)
    s_barrier
    v_mfma_f32_32x32x16_bf16 v[16:31], a[80:83], v[48:51], v[16:31]
    ds_read_b128 v[80:83], v4 offset:34176
    s_waitcnt vmcnt(9)
    ds_read_b64_tr_b16 v[192:193], v180 offset:0
    ds_read_b64_tr_b16 v[194:195], v180 offset:512
    v_fma_f32 v130, v130, v101, v101
    v_mfma_f32_32x32x16_bf16 v[16:31], a[84:87], v[52:55], v[16:31]
    ds_read_b128 v[84:87], v4 offset:34208
    ds_read_b64_tr_b16 v[196:197], v181 offset:0
    ds_read_b64_tr_b16 v[198:199], v181 offset:512
    v_rcp_f32 v129, v129
    v_fma_f32 v131, v131, v101, v101
    v_mfma_f32_32x32x16_bf16 v[16:31], a[88:91], v[56:59], v[16:31]
    ds_read_b128 v[88:91], v4 offset:34240
    ds_read_b64_tr_b16 v[200:201], v180 offset:2048
    ds_read_b64_tr_b16 v[202:203], v180 offset:2560
    v_rcp_f32 v130, v130
    v_mfma_f32_32x32x16_bf16 v[16:31], a[92:95], v[60:63], v[16:31]
    ds_read_b128 v[92:95], v4 offset:34272
    ds_read_b64_tr_b16 v[204:205], v181 offset:2048
    ds_read_b64_tr_b16 v[206:207], v181 offset:2560
    v_fma_f32 v132, v132, v101, v101
    s_waitcnt lgkmcnt(12)
    v_mfma_f32_32x32x16_bf16 v[16:31], a[96:99], v[64:67], v[16:31]
    ds_read_b128 v[48:51], v3 offset:0
    v_rcp_f32 v131, v131
    v_fma_f32 v133, v133, v101, v101
    v_rcp_f32 v132, v132
    v_mfma_f32_32x32x16_bf16 v[16:31], a[100:103], v[68:71], v[16:31]
    ds_read_b128 v[52:55], v3 offset:32
    s_waitcnt lgkmcnt(2)
    s_mov_b32 m0, s48
    s_bfe_u32 s84, s53, 262148
    s_lshl_b32 s84, s84, 15
    s_add_u32 s84, s84, s83
    buffer_load_dwordx4 v174, s[20:23], s84 offen offset:0 lds
    v_mfma_f32_32x32x16_bf16 v[16:31], a[104:107], v[72:75], v[16:31]
    ds_read_b128 v[56:59], v3 offset:64
    v_fma_f32 v134, v134, v101, v101
    v_rcp_f32 v133, v133
    v_fma_f32 v135, v135, v101, v101
    v_rcp_f32 v134, v134
    v_mfma_f32_32x32x16_bf16 v[16:31], a[108:111], v[76:79], v[16:31]
    ds_read_b128 v[60:63], v3 offset:96
    buffer_load_dwordx4 v175, s[20:23], s84 offen offset:1024 lds
    v_mfma_f32_32x32x16_bf16 v[16:31], a[112:115], v[80:83], v[16:31]
    ds_read_b128 v[64:67], v3 offset:128
    v_rcp_f32 v135, v135
    v_mul_f32 v128, v40, v128
    v_mul_f32 v129, v41, v129
    v_mul_f32 v130, v42, v130
    v_mul_f32 v131, v43, v131
    v_mfma_f32_32x32x16_bf16 v[16:31], a[116:119], v[84:87], v[16:31]
    ds_read_b128 v[68:71], v3 offset:160
    buffer_load_dwordx4 v176, s[20:23], s84 offen offset:2048 lds
    v_mul_f32 v132, v44, v132
    v_mul_f32 v133, v45, v133
    v_mfma_f32_32x32x16_bf16 v[16:31], a[120:123], v[88:91], v[16:31]
    ds_read_b128 v[72:75], v3 offset:192
    v_mul_f32 v134, v46, v134
    v_mul_f32 v135, v47, v135
    v_cvt_pk_bf16_f32 v140, v128, v129
    v_cvt_pk_bf16_f32 v141, v130, v131
    v_cvt_pk_bf16_f32 v142, v132, v133
    v_mfma_f32_32x32x16_bf16 v[16:31], a[124:127], v[92:95], v[16:31]
    ds_read_b128 v[76:79], v3 offset:224
    buffer_load_dwordx4 v177, s[20:23], s84 offen offset:3072 lds
    v_cvt_pk_bf16_f32 v143, v134, v135
    buffer_store_dwordx4 v[140:143], v2, s[36:39], s73 offen sc1
    v_mfma_f32_32x32x16_bf16 v[32:47], v[152:155], v[160:163], 0
    s_add_u32 m0, s49, 66560
    s_nop 0
    buffer_load_dwordx4 v8, s[8:11], s69 offen offset:0  lds
    s_mul_i32 s90, s3, 2304
    s_add_u32 s90, s90, 134144
    s_waitcnt lgkmcnt(4)
    v_mfma_f32_32x32x16_bf16 v[32:47], a[0:3], v[48:51], v[32:47]
    ds_read_b128 v[80:83], v3 offset:256
    v_lshrrev_b32 v248, 3, v1
    v_and_b32 v249, 7, v1
    v_lshlrev_b32 v249, 4, v249
    v_mul_f32 v144, v106, v106
    v_mul_f32 v144, 0x3c0a3963, v144
    v_mfma_f32_32x32x16_bf16 v[32:47], a[4:7], v[52:55], v[32:47]
    ds_read_b128 v[84:87], v3 offset:288
    buffer_load_dwordx4 v9, s[8:11], s69 offen offset:1040  lds
    v_mul_u32_u24 v191, 144, v248
    v_add3_u32 v191, v191, v249, s90
    v_mul_f32 v128, v16, v16
    v_mfma_f32_32x32x16_bf16 v[32:47], a[8:11], v[56:59], v[32:47]
    ds_read_b128 v[88:91], v3 offset:320
    ds_read_b128 v[240:243], v191
    ds_read_b128 v[244:247], v191 offset:1152
    v_mul_f32 v129, v17, v17
    v_mfma_f32_32x32x16_bf16 v[32:47], a[12:15], v[60:63], v[32:47]
    ds_read_b128 v[92:95], v3 offset:352
    v_lshl_add_u32 v248, v248, 13, v249
    s_and_b32 s90, s2, 3
    s_lshl_b32 s90, s90, 2
    v_mul_f32 v130, v18, v18
    v_mul_f32 v131, v19, v19
    s_waitcnt lgkmcnt(6)
    v_mfma_f32_32x32x16_bf16 v[32:47], a[16:19], v[64:67], v[32:47]
    ds_read_b128 v[48:51], v3 offset:384
    buffer_load_dwordx4 v10, s[8:11], s69 offen offset:2080  lds
    s_add_u32 s90, s90, s3
    s_lshl_b32 s90, s90, 17
    v_mul_f32 v132, v20, v20
    v_mul_f32 v133, v21, v21
    v_mfma_f32_32x32x16_bf16 v[32:47], a[20:23], v[68:71], v[32:47]
    ds_read_b128 v[52:55], v3 offset:416
    s_and_b32 s91, s2, 0xfc
    s_lshl_b32 s91, s91, 5
    s_add_u32 s90, s90, s91
    v_mul_f32 v134, v22, v22
    v_mul_f32 v135, v23, v23
    v_mul_f32 v144, v144, v106
    v_mfma_f32_32x32x16_bf16 v[32:47], a[24:27], v[72:75], v[32:47]
    ds_read_b128 v[56:59], v3 offset:448
    buffer_load_dwordx4 v11, s[8:11], s69 offen offset:3120  lds
    s_add_u32 s90, s90, 3145728
    s_add_u32 s91, s90, 65536
    v_fma_f32 v128, v144, v128, v106
    v_fma_f32 v129, v144, v129, v106
    v_mfma_f32_32x32x16_bf16 v[32:47], a[28:31], v[76:79], v[32:47]
    ds_read_b128 v[60:63], v3 offset:480
    v_fma_f32 v130, v144, v130, v106
    v_fma_f32 v131, v144, v131, v106
    v_fma_f32 v132, v144, v132, v106
    v_fma_f32 v133, v144, v133, v106
    s_waitcnt lgkmcnt(4)
    v_mfma_f32_32x32x16_bf16 v[32:47], a[32:35], v[80:83], v[32:47]
    ds_read_b128 v[64:67], v3 offset:512
    buffer_store_dwordx4 v[240:243], v248, s[36:39], s90 offen sc1
    v_fma_f32 v134, v144, v134, v106
    v_fma_f32 v135, v144, v135, v106
    v_mfma_f32_32x32x16_bf16 v[32:47], a[36:39], v[84:87], v[32:47]
    ds_read_b128 v[68:71], v3 offset:544
    s_add_u32 m0, s49, 70720
    s_add_u32 s69, s69, 524288
    buffer_load_dwordx4 v8, s[8:11], s69 offen offset:0  lds
    v_mul_f32 v128, v16, v128
    v_mul_f32 v129, v17, v129
    v_mfma_f32_32x32x16_bf16 v[32:47], a[40:43], v[88:91], v[32:47]
    ds_read_b128 v[72:75], v3 offset:576
    v_mul_f32 v130, v18, v130
    v_mul_f32 v131, v19, v131
    v_mul_f32 v132, v20, v132
    v_mul_f32 v133, v21, v133
    v_mul_f32 v134, v22, v134
    v_mfma_f32_32x32x16_bf16 v[32:47], a[44:47], v[92:95], v[32:47]
    ds_read_b128 v[76:79], v3 offset:608
    buffer_load_dwordx4 v9, s[8:11], s69 offen offset:1040  lds
    buffer_store_dwordx4 v[244:247], v248, s[36:39], s91 offen sc1
    s_waitcnt lgkmcnt(4)
    v_mfma_f32_32x32x16_bf16 v[32:47], a[48:51], v[48:51], v[32:47]
    ds_read_b128 v[80:83], v3 offset:640
    v_mul_f32 v135, v23, v135
    v_exp_f32 v128, v128
    v_mul_f32 v24, v16, v24
    v_exp_f32 v129, v129
    v_mfma_f32_32x32x16_bf16 v[32:47], a[52:55], v[52:55], v[32:47]
    ds_read_b128 v[84:87], v3 offset:672
    v_mul_f32 v25, v17, v25
    v_exp_f32 v130, v130
    v_mul_f32 v26, v18, v26
    v_mfma_f32_32x32x16_bf16 v[32:47], a[56:59], v[56:59], v[32:47]
    ds_read_b128 v[88:91], v3 offset:704
    buffer_load_dwordx4 v10, s[8:11], s69 offen offset:2080  lds
    v_exp_f32 v131, v131
    v_mul_f32 v27, v19, v27
    v_mfma_f32_32x32x16_bf16 v[32:47], a[60:63], v[60:63], v[32:47]
    ds_read_b128 v[92:95], v3 offset:736
    v_exp_f32 v132, v132
    v_mul_f32 v28, v20, v28
    s_waitcnt lgkmcnt(4)
    v_mfma_f32_32x32x16_bf16 v[32:47], a[64:67], v[64:67], v[32:47]
    ds_read_b128 v[48:51], v3 offset:768
    buffer_load_dwordx4 v11, s[8:11], s69 offen offset:3120  lds
    v_exp_f32 v133, v133
    v_mul_f32 v29, v21, v29
    v_mfma_f32_32x32x16_bf16 v[32:47], a[68:71], v[68:71], v[32:47]
    ds_read_b128 v[52:55], v3 offset:800
    v_exp_f32 v134, v134
    v_mov_b32 v156, v112
    v_mov_b32 v157, v112
    v_mul_f32 v30, v22, v30
    v_mfma_f32_32x32x16_bf16 v[32:47], a[72:75], v[72:75], v[32:47]
    ds_read_b128 v[56:59], v3 offset:832
    v_exp_f32 v135, v135
    v_mul_f32 v31, v23, v31
    v_fma_f32 v128, v128, v105, v105
    v_fma_f32 v129, v129, v105, v105
    v_mfma_f32_32x32x16_bf16 v[32:47], a[76:79], v[76:79], v[32:47]
    ds_read_b128 v[60:63], v3 offset:864
    s_waitcnt vmcnt(15)
    s_barrier
    s_waitcnt lgkmcnt(4)
    v_mfma_f32_32x32x16_bf16 v[32:47], a[80:83], v[80:83], v[32:47]
    ds_read_b128 v[64:67], v3 offset:896
    s_waitcnt vmcnt(11)
    ds_read_b64_tr_b16 v[208:209], v180 offset:0
    ds_read_b64_tr_b16 v[210:211], v180 offset:512
    v_rcp_f32 v128, v128
    v_mfma_f32_32x32x16_bf16 v[32:47], a[84:87], v[84:87], v[32:47]
    ds_read_b128 v[68:71], v3 offset:928
    ds_read_b64_tr_b16 v[212:213], v181 offset:0
    ds_read_b64_tr_b16 v[214:215], v181 offset:512
    v_fma_f32 v130, v130, v105, v105
    v_rcp_f32 v129, v129
    v_mfma_f32_32x32x16_bf16 v[32:47], a[88:91], v[88:91], v[32:47]
    ds_read_b128 v[72:75], v3 offset:960
    ds_read_b64_tr_b16 v[216:217], v180 offset:2048
    ds_read_b64_tr_b16 v[218:219], v180 offset:2560
    v_fma_f32 v131, v131, v105, v105
    v_rcp_f32 v130, v130
    v_mfma_f32_32x32x16_bf16 v[32:47], a[92:95], v[92:95], v[32:47]
    ds_read_b128 v[76:79], v3 offset:992
    ds_read_b64_tr_b16 v[220:221], v181 offset:2048
    ds_read_b64_tr_b16 v[222:223], v181 offset:2560
    v_fma_f32 v132, v132, v105, v105
    s_waitcnt lgkmcnt(12)
    v_mfma_f32_32x32x16_bf16 v[32:47], a[96:99], v[48:51], v[32:47]
    ds_read_b128 v[80:83], v3 offset:33280
    v_rcp_f32 v131, v131
    v_fma_f32 v133, v133, v105, v105
    v_rcp_f32 v132, v132
    v_mfma_f32_32x32x16_bf16 v[32:47], a[100:103], v[52:55], v[32:47]
    ds_read_b128 v[84:87], v3 offset:33312
    s_waitcnt lgkmcnt(2)
    s_mov_b32 m0, s48
    s_bfe_u32 s84, s53, 262152
    s_lshl_b32 s84, s84, 15
    s_add_u32 s84, s84, s83
    buffer_load_dwordx4 v174, s[20:23], s84 offen offset:0 lds
    v_mfma_f32_32x32x16_bf16 v[32:47], a[104:107], v[56:59], v[32:47]
    ds_read_b128 v[88:91], v3 offset:33344
    v_fma_f32 v134, v134, v105, v105
    v_rcp_f32 v133, v133
    v_fma_f32 v135, v135, v105, v105
    v_mfma_f32_32x32x16_bf16 v[32:47], a[108:111], v[60:63], v[32:47]
    ds_read_b128 v[92:95], v3 offset:33376
    buffer_load_dwordx4 v175, s[20:23], s84 offen offset:1024 lds
    v_rcp_f32 v134, v134
    v_mfma_f32_32x32x16_bf16 v[32:47], a[112:115], v[64:67], v[32:47]
    ds_read_b128 v[48:51], v3 offset:33408
    v_rcp_f32 v135, v135
    v_mul_f32 v128, v24, v128
    v_mul_f32 v129, v25, v129
    v_mul_f32 v130, v26, v130
    v_mfma_f32_32x32x16_bf16 v[32:47], a[116:119], v[68:71], v[32:47]
    ds_read_b128 v[52:55], v3 offset:33440
    buffer_load_dwordx4 v176, s[20:23], s84 offen offset:2048 lds
    v_mul_f32 v131, v27, v131
    v_mul_f32 v132, v28, v132
    v_mul_f32 v133, v29, v133
    v_mfma_f32_32x32x16_bf16 v[32:47], a[120:123], v[72:75], v[32:47]
    ds_read_b128 v[56:59], v3 offset:33472
    v_mul_f32 v134, v30, v134
    v_mul_f32 v135, v31, v135
    v_cvt_pk_bf16_f32 v136, v128, v129
    v_cvt_pk_bf16_f32 v137, v130, v131
    v_cvt_pk_bf16_f32 v138, v132, v133
    v_mfma_f32_32x32x16_bf16 v[32:47], a[124:127], v[76:79], v[32:47]
    ds_read_b128 v[60:63], v3 offset:33504
    buffer_load_dwordx4 v177, s[20:23], s84 offen offset:3072 lds
    v_cvt_pk_bf16_f32 v139, v134, v135
    buffer_store_dwordx4 v[136:139], v2, s[36:39], s74 offen sc1
    v_mfma_f32_32x32x16_bf16 v[16:31], v[152:155], v[156:159], 0
    s_add_u32 m0, s49, 99840
    s_nop 0
    buffer_load_dwordx4 v8, s[8:11], s70 offen offset:0  lds
    s_waitcnt lgkmcnt(4)
    v_mfma_f32_32x32x16_bf16 v[16:31], a[0:3], v[80:83], v[16:31]
    ds_read_b128 v[64:67], v3 offset:33536
    v_mul_f32 v144, v110, v110
    v_mul_f32 v144, 0x3c0a3963, v144
    v_mul_f32 v128, v32, v32
    v_mul_f32 v129, v33, v33
    v_mfma_f32_32x32x16_bf16 v[16:31], a[4:7], v[84:87], v[16:31]
    ds_read_b128 v[68:71], v3 offset:33568
    buffer_load_dwordx4 v9, s[8:11], s70 offen offset:1040  lds
    v_mul_f32 v130, v34, v34
    v_mul_f32 v131, v35, v35
    v_mul_f32 v132, v36, v36
    v_mfma_f32_32x32x16_bf16 v[16:31], a[8:11], v[88:91], v[16:31]
    ds_read_b128 v[72:75], v3 offset:33600
    v_mul_f32 v133, v37, v37
    v_mul_f32 v134, v38, v38
    v_mul_f32 v135, v39, v39
    v_mul_f32 v144, v144, v110
    v_mfma_f32_32x32x16_bf16 v[16:31], a[12:15], v[92:95], v[16:31]
    ds_read_b128 v[76:79], v3 offset:33632
    v_fma_f32 v128, v144, v128, v110
    v_fma_f32 v129, v144, v129, v110
    v_fma_f32 v130, v144, v130, v110
    v_fma_f32 v131, v144, v131, v110
    s_waitcnt lgkmcnt(4)
    v_mfma_f32_32x32x16_bf16 v[16:31], a[16:19], v[48:51], v[16:31]
    ds_read_b128 v[80:83], v3 offset:33664
    buffer_load_dwordx4 v10, s[8:11], s70 offen offset:2080  lds
    v_fma_f32 v132, v144, v132, v110
    v_fma_f32 v133, v144, v133, v110
    v_mfma_f32_32x32x16_bf16 v[16:31], a[20:23], v[52:55], v[16:31]
    ds_read_b128 v[84:87], v3 offset:33696
    v_fma_f32 v134, v144, v134, v110
    v_fma_f32 v135, v144, v135, v110
    v_mul_f32 v128, v32, v128
    v_mul_f32 v129, v33, v129
    v_mfma_f32_32x32x16_bf16 v[16:31], a[24:27], v[56:59], v[16:31]
    ds_read_b128 v[88:91], v3 offset:33728
    buffer_load_dwordx4 v11, s[8:11], s70 offen offset:3120  lds
    v_mul_f32 v130, v34, v130
    v_mul_f32 v131, v35, v131
    v_mul_f32 v132, v36, v132
    v_mfma_f32_32x32x16_bf16 v[16:31], a[28:31], v[60:63], v[16:31]
    ds_read_b128 v[92:95], v3 offset:33760
    s_and_b32 s90, s2, 3
    s_lshl_b32 s90, s90, 2
    s_add_u32 s90, s90, s3
    s_lshl_b32 s90, s90, 13
    s_and_b32 s91, s2, 0xfc
    s_lshl_b32 s91, s91, 5
    s_add_u32 s90, s90, s91
    s_add_u32 s90, s90, 524288
    s_waitcnt vmcnt(11)
    v_mov_b32 v14, s40
    v_mov_b32 v15, 0
    s_mov_b64 exec, 1
    buffer_store_dword v14, v15, s[36:39], s90 offen sc1
    s_mov_b64 exec, -1
    s_waitcnt lgkmcnt(4)
    s_nop 2
    v_mfma_f32_32x32x16_bf16 v[16:31], a[32:35], v[64:67], v[16:31]
    ds_read_b128 v[48:51], v3 offset:33792
    v_mul_f32 v133, v37, v133
    v_mul_f32 v134, v38, v134
    v_mul_f32 v135, v39, v135
    v_exp_f32 v128, v128
    v_mfma_f32_32x32x16_bf16 v[16:31], a[36:39], v[68:71], v[16:31]
    ds_read_b128 v[52:55], v3 offset:33824
    s_add_u32 m0, s49, 104000
    s_add_u32 s70, s70, 524288
    buffer_load_dwordx4 v8, s[8:11], s70 offen offset:0  lds
    v_mfma_f32_32x32x16_bf16 v[16:31], a[40:43], v[72:75], v[16:31]
    ds_read_b128 v[56:59], v3 offset:33856
    v_mul_f32 v40, v32, v40
    v_exp_f32 v129, v129
    v_mul_f32 v41, v33, v41
    v_mfma_f32_32x32x16_bf16 v[16:31], a[44:47], v[76:79], v[16:31]
    ds_read_b128 v[60:63], v3 offset:33888
    buffer_load_dwordx4 v9, s[8:11], s70 offen offset:1040  lds
    v_exp_f32 v130, v130
    s_waitcnt lgkmcnt(4)
    v_mfma_f32_32x32x16_bf16 v[16:31], a[48:51], v[80:83], v[16:31]
    ds_read_b128 v[64:67], v3 offset:33920
    v_mul_f32 v42, v34, v42
    v_exp_f32 v131, v131
    v_mul_f32 v43, v35, v43
    v_mfma_f32_32x32x16_bf16 v[16:31], a[52:55], v[84:87], v[16:31]
    ds_read_b128 v[68:71], v3 offset:33952
    v_exp_f32 v132, v132
    v_mul_f32 v44, v36, v44
    v_exp_f32 v133, v133
    v_mfma_f32_32x32x16_bf16 v[16:31], a[56:59], v[88:91], v[16:31]
    ds_read_b128 v[72:75], v3 offset:33984
    buffer_load_dwordx4 v10, s[8:11], s70 offen offset:2080  lds
    v_mul_f32 v45, v37, v45
    v_exp_f32 v134, v134
    v_mfma_f32_32x32x16_bf16 v[16:31], a[60:63], v[92:95], v[16:31]
    ds_read_b128 v[76:79], v3 offset:34016
    v_mov_b32 v160, v116
    v_mov_b32 v161, v116
    v_mul_f32 v46, v38, v46
    s_waitcnt lgkmcnt(4)
    v_mfma_f32_32x32x16_bf16 v[16:31], a[64:67], v[48:51], v[16:31]
    ds_read_b128 v[80:83], v3 offset:34048
    buffer_load_dwordx4 v11, s[8:11], s70 offen offset:3120  lds
    v_exp_f32 v135, v135
    v_mfma_f32_32x32x16_bf16 v[16:31], a[68:71], v[52:55], v[16:31]
    ds_read_b128 v[84:87], v3 offset:34080
    v_mul_f32 v47, v39, v47
    v_fma_f32 v128, v128, v109, v109
    v_fma_f32 v129, v129, v109, v109
    v_rcp_f32 v128, v128
    v_mfma_f32_32x32x16_bf16 v[16:31], a[72:75], v[56:59], v[16:31]
    ds_read_b128 v[88:91], v3 offset:34112
    v_fma_f32 v130, v130, v109, v109
    v_rcp_f32 v129, v129
    v_fma_f32 v131, v131, v109, v109
    v_mfma_f32_32x32x16_bf16 v[16:31], a[76:79], v[60:63], v[16:31]
    ds_read_b128 v[92:95], v3 offset:34144
    s_waitcnt vmcnt(14)
    s_barrier
    s_waitcnt lgkmcnt(4)
    v_mfma_f32_32x32x16_bf16 v[16:31], a[80:83], v[64:67], v[16:31]
    ds_read_b128 v[48:51], v3 offset:34176
    s_waitcnt vmcnt(10)
    ds_read_b64_tr_b16 v[224:225], v180 offset:0
    ds_read_b64_tr_b16 v[226:227], v180 offset:512
    v_rcp_f32 v130, v130
    v_mfma_f32_32x32x16_bf16 v[16:31], a[84:87], v[68:71], v[16:31]
    ds_read_b128 v[52:55], v3 offset:34208
    ds_read_b64_tr_b16 v[228:229], v181 offset:0
    ds_read_b64_tr_b16 v[230:231], v181 offset:512
    v_fma_f32 v132, v132, v109, v109
    v_mfma_f32_32x32x16_bf16 v[16:31], a[88:91], v[72:75], v[16:31]
    ds_read_b128 v[56:59], v3 offset:34240
    ds_read_b64_tr_b16 v[232:233], v180 offset:2048
    ds_read_b64_tr_b16 v[234:235], v180 offset:2560
    v_rcp_f32 v131, v131
    v_mfma_f32_32x32x16_bf16 v[16:31], a[92:95], v[76:79], v[16:31]
    ds_read_b128 v[60:63], v3 offset:34272
    ds_read_b64_tr_b16 v[236:237], v181 offset:2048
    ds_read_b64_tr_b16 v[238:239], v181 offset:2560
    v_fma_f32 v133, v133, v109, v109
    s_waitcnt lgkmcnt(12)
    v_mfma_f32_32x32x16_bf16 v[16:31], a[96:99], v[80:83], v[16:31]
    ds_read_b128 v[64:67], v4 offset:0
    v_rcp_f32 v132, v132
    v_fma_f32 v134, v134, v109, v109
    v_rcp_f32 v133, v133
    v_mfma_f32_32x32x16_bf16 v[16:31], a[100:103], v[84:87], v[16:31]
    ds_read_b128 v[68:71], v4 offset:32
    s_waitcnt lgkmcnt(2)
    s_mov_b32 m0, s48
    s_bfe_u32 s84, s53, 262156
    s_lshl_b32 s84, s84, 15
    s_add_u32 s84, s84, s83
    buffer_load_dwordx4 v174, s[20:23], s84 offen offset:0 lds
    v_mfma_f32_32x32x16_bf16 v[16:31], a[104:107], v[88:91], v[16:31]
    ds_read_b128 v[72:75], v4 offset:64
    v_fma_f32 v135, v135, v109, v109
    v_rcp_f32 v134, v134
    v_mfma_f32_32x32x16_bf16 v[16:31], a[108:111], v[92:95], v[16:31]
    ds_read_b128 v[76:79], v4 offset:96
    buffer_load_dwordx4 v175, s[20:23], s84 offen offset:1024 lds
    v_rcp_f32 v135, v135
    v_mfma_f32_32x32x16_bf16 v[16:31], a[112:115], v[48:51], v[16:31]
    ds_read_b128 v[80:83], v4 offset:128
    v_mul_f32 v128, v40, v128
    v_mul_f32 v129, v41, v129
    v_mul_f32 v130, v42, v130
    v_mul_f32 v131, v43, v131
    v_mul_f32 v132, v44, v132
    v_mfma_f32_32x32x16_bf16 v[16:31], a[116:119], v[52:55], v[16:31]
    ds_read_b128 v[84:87], v4 offset:160
    buffer_load_dwordx4 v176, s[20:23], s84 offen offset:2048 lds
    v_mul_f32 v133, v45, v133
    v_mul_f32 v134, v46, v134
    v_mfma_f32_32x32x16_bf16 v[16:31], a[120:123], v[56:59], v[16:31]
    ds_read_b128 v[88:91], v4 offset:192
    v_mul_f32 v135, v47, v135
    v_cvt_pk_bf16_f32 v140, v128, v129
    v_cvt_pk_bf16_f32 v141, v130, v131
    v_cvt_pk_bf16_f32 v142, v132, v133
    v_cvt_pk_bf16_f32 v143, v134, v135
    v_mfma_f32_32x32x16_bf16 v[16:31], a[124:127], v[60:63], v[16:31]
    ds_read_b128 v[92:95], v4 offset:224
    buffer_load_dwordx4 v177, s[20:23], s84 offen offset:3072 lds
    buffer_store_dwordx4 v[140:143], v2, s[36:39], s75 offen sc1
    v_mfma_f32_32x32x16_bf16 v[32:47], v[152:155], v[160:163], 0
    s_add_u32 m0, s49, 0
    s_nop 0
    buffer_load_dwordx4 v8, s[8:11], s71 offen offset:0  lds
    s_waitcnt lgkmcnt(4)
    v_mfma_f32_32x32x16_bf16 v[32:47], a[0:3], v[64:67], v[32:47]
    ds_read_b128 v[48:51], v4 offset:256
    v_mul_f32 v144, v114, v114
    v_mul_f32 v144, 0x3c0a3963, v144
    v_mul_f32 v128, v16, v16
    v_mul_f32 v129, v17, v17
    v_mfma_f32_32x32x16_bf16 v[32:47], a[4:7], v[68:71], v[32:47]
    ds_read_b128 v[52:55], v4 offset:288
    buffer_load_dwordx4 v9, s[8:11], s71 offen offset:1040  lds
    v_mul_f32 v130, v18, v18
    v_mul_f32 v131, v19, v19
    v_mul_f32 v132, v20, v20
    v_mfma_f32_32x32x16_bf16 v[32:47], a[8:11], v[72:75], v[32:47]
    ds_read_b128 v[56:59], v4 offset:320
    v_mul_f32 v133, v21, v21
    v_mul_f32 v134, v22, v22
    v_mul_f32 v135, v23, v23
    v_mul_f32 v144, v144, v114
    v_mfma_f32_32x32x16_bf16 v[32:47], a[12:15], v[76:79], v[32:47]
    ds_read_b128 v[60:63], v4 offset:352
    v_fma_f32 v128, v144, v128, v114
    v_fma_f32 v129, v144, v129, v114
    v_fma_f32 v130, v144, v130, v114
    v_fma_f32 v131, v144, v131, v114
    s_waitcnt lgkmcnt(4)
    v_mfma_f32_32x32x16_bf16 v[32:47], a[16:19], v[80:83], v[32:47]
    ds_read_b128 v[64:67], v4 offset:384
    buffer_load_dwordx4 v10, s[8:11], s71 offen offset:2080  lds
    v_fma_f32 v132, v144, v132, v114
    v_fma_f32 v133, v144, v133, v114
    v_mfma_f32_32x32x16_bf16 v[32:47], a[20:23], v[84:87], v[32:47]
    ds_read_b128 v[68:71], v4 offset:416
    v_fma_f32 v134, v144, v134, v114
    v_fma_f32 v135, v144, v135, v114
    v_mul_f32 v128, v16, v128
    v_mul_f32 v129, v17, v129
    v_mul_f32 v130, v18, v130
    v_mfma_f32_32x32x16_bf16 v[32:47], a[24:27], v[88:91], v[32:47]
    ds_read_b128 v[72:75], v4 offset:448
    buffer_load_dwordx4 v11, s[8:11], s71 offen offset:3120  lds
    v_mul_f32 v131, v19, v131
    v_mul_f32 v132, v20, v132
    v_mfma_f32_32x32x16_bf16 v[32:47], a[28:31], v[92:95], v[32:47]
    ds_read_b128 v[76:79], v4 offset:480
    v_mul_f32 v133, v21, v133
    v_mul_f32 v134, v22, v134
    v_mul_f32 v135, v23, v135
    s_waitcnt lgkmcnt(4)
    v_mfma_f32_32x32x16_bf16 v[32:47], a[32:35], v[48:51], v[32:47]
    ds_read_b128 v[80:83], v4 offset:512
    v_exp_f32 v128, v128
    v_mul_f32 v24, v16, v24
    v_exp_f32 v129, v129
    v_mfma_f32_32x32x16_bf16 v[32:47], a[36:39], v[52:55], v[32:47]
    ds_read_b128 v[84:87], v4 offset:544
    s_add_u32 m0, s49, 4160
    s_add_u32 s71, s71, 524288
    buffer_load_dwordx4 v8, s[8:11], s71 offen offset:0  lds
    v_mul_f32 v25, v17, v25
    v_mfma_f32_32x32x16_bf16 v[32:47], a[40:43], v[56:59], v[32:47]
    ds_read_b128 v[88:91], v4 offset:576
    v_exp_f32 v130, v130
    v_mul_f32 v26, v18, v26
    v_exp_f32 v131, v131
    v_mfma_f32_32x32x16_bf16 v[32:47], a[44:47], v[60:63], v[32:47]
    ds_read_b128 v[92:95], v4 offset:608
    buffer_load_dwordx4 v9, s[8:11], s71 offen offset:1040  lds
    v_mul_f32 v27, v19, v27
    s_waitcnt lgkmcnt(4)
    v_mfma_f32_32x32x16_bf16 v[32:47], a[48:51], v[64:67], v[32:47]
    ds_read_b128 v[48:51], v4 offset:640
    v_exp_f32 v132, v132
    v_mul_f32 v28, v20, v28
    v_exp_f32 v133, v133
    v_mfma_f32_32x32x16_bf16 v[32:47], a[52:55], v[68:71], v[32:47]
    ds_read_b128 v[52:55], v4 offset:672
    v_mul_f32 v29, v21, v29
    v_exp_f32 v134, v134
    v_mov_b32 v156, v120
    v_mfma_f32_32x32x16_bf16 v[32:47], a[56:59], v[72:75], v[32:47]
    ds_read_b128 v[56:59], v4 offset:704
    buffer_load_dwordx4 v10, s[8:11], s71 offen offset:2080  lds
    v_mov_b32 v157, v120
    v_mul_f32 v30, v22, v30
    v_mfma_f32_32x32x16_bf16 v[32:47], a[60:63], v[76:79], v[32:47]
    ds_read_b128 v[60:63], v4 offset:736
    v_exp_f32 v135, v135
    v_mul_f32 v31, v23, v31
    v_fma_f32 v128, v128, v113, v113
    s_waitcnt lgkmcnt(4)
    v_mfma_f32_32x32x16_bf16 v[32:47], a[64:67], v[80:83], v[32:47]
    ds_read_b128 v[64:67], v4 offset:768
    buffer_load_dwordx4 v11, s[8:11], s71 offen offset:3120  lds
    v_fma_f32 v129, v129, v113, v113
    v_rcp_f32 v128, v128
    v_mfma_f32_32x32x16_bf16 v[32:47], a[68:71], v[84:87], v[32:47]
    ds_read_b128 v[68:71], v4 offset:800
    v_fma_f32 v130, v130, v113, v113
    v_rcp_f32 v129, v129
    v_fma_f32 v131, v131, v113, v113
    v_mfma_f32_32x32x16_bf16 v[32:47], a[72:75], v[88:91], v[32:47]
    ds_read_b128 v[72:75], v4 offset:832
    v_rcp_f32 v130, v130
    v_fma_f32 v132, v132, v113, v113
    v_rcp_f32 v131, v131
    v_mfma_f32_32x32x16_bf16 v[32:47], a[76:79], v[92:95], v[32:47]
    ds_read_b128 v[76:79], v4 offset:864
    s_waitcnt vmcnt(8)
    s_barrier
    s_waitcnt lgkmcnt(4)
    v_mfma_f32_32x32x16_bf16 v[32:47], a[80:83], v[48:51], v[32:47]
    ds_read_b128 v[80:83], v4 offset:896
    buffer_load_dword v182, v172, s[36:39], s80 offen sc1
    ds_read_b64_tr_b16 v[240:241], v180 offset:0
    ds_read_b64_tr_b16 v[242:243], v180 offset:512
    v_mfma_f32_32x32x16_bf16 v[32:47], a[84:87], v[52:55], v[32:47]
    ds_read_b128 v[84:87], v4 offset:928
    ds_read_b64_tr_b16 v[244:245], v181 offset:0
    ds_read_b64_tr_b16 v[246:247], v181 offset:512
    v_mov_b32 v14, s40
    v_mov_b32 v15, 0
    s_nop 0
    s_mov_b64 exec, 1
    buffer_store_dword v14, v15, s[36:39], s50 offen sc1
    s_mov_b64 exec, -1
    s_add_u32 s50, s50, 0x8000
    s_nop 2
    v_mfma_f32_32x32x16_bf16 v[32:47], a[88:91], v[56:59], v[32:47]
    ds_read_b128 v[88:91], v4 offset:960
    buffer_load_dword v183, v173, s[36:39], s81 offen sc1
    ds_read_b64_tr_b16 v[248:249], v180 offset:2048
    ds_read_b64_tr_b16 v[250:251], v180 offset:2560
    v_mfma_f32_32x32x16_bf16 v[32:47], a[92:95], v[60:63], v[32:47]
    ds_read_b128 v[92:95], v4 offset:992
    ds_read_b64_tr_b16 v[252:253], v181 offset:2048
    ds_read_b64_tr_b16 v[254:255], v181 offset:2560
    v_fma_f32 v133, v133, v113, v113
    s_waitcnt lgkmcnt(12)
    v_mfma_f32_32x32x16_bf16 v[32:47], a[96:99], v[64:67], v[32:47]
    ds_read_b128 v[48:51], v4 offset:33280
    v_rcp_f32 v132, v132
    v_fma_f32 v134, v134, v113, v113
    v_rcp_f32 v133, v133
    v_mfma_f32_32x32x16_bf16 v[32:47], a[100:103], v[68:71], v[32:47]
    ds_read_b128 v[52:55], v4 offset:33312
    s_waitcnt lgkmcnt(2)
    s_mov_b32 m0, s48
    s_bfe_u32 s84, s53, 262160
    s_lshl_b32 s84, s84, 15
    s_add_u32 s84, s84, s83
    buffer_load_dwordx4 v174, s[20:23], s84 offen offset:0 lds
    v_mfma_f32_32x32x16_bf16 v[32:47], a[104:107], v[72:75], v[32:47]
    ds_read_b128 v[56:59], v4 offset:33344
    v_fma_f32 v135, v135, v113, v113
    v_rcp_f32 v134, v134
    v_mfma_f32_32x32x16_bf16 v[32:47], a[108:111], v[76:79], v[32:47]
    ds_read_b128 v[60:63], v4 offset:33376
    buffer_load_dwordx4 v175, s[20:23], s84 offen offset:1024 lds
    v_rcp_f32 v135, v135
    v_mfma_f32_32x32x16_bf16 v[32:47], a[112:115], v[80:83], v[32:47]
    ds_read_b128 v[64:67], v4 offset:33408
    v_mul_f32 v128, v24, v128
    v_mul_f32 v129, v25, v129
    v_mul_f32 v130, v26, v130
    v_mul_f32 v131, v27, v131
    v_mul_f32 v132, v28, v132
    v_mfma_f32_32x32x16_bf16 v[32:47], a[116:119], v[84:87], v[32:47]
    ds_read_b128 v[68:71], v4 offset:33440
    buffer_load_dwordx4 v176, s[20:23], s84 offen offset:2048 lds
    v_mul_f32 v133, v29, v133
    v_mul_f32 v134, v30, v134
    v_mfma_f32_32x32x16_bf16 v[32:47], a[120:123], v[88:91], v[32:47]
    ds_read_b128 v[72:75], v4 offset:33472
    v_mul_f32 v135, v31, v135
    v_cvt_pk_bf16_f32 v136, v128, v129
    v_cvt_pk_bf16_f32 v137, v130, v131
    v_cvt_pk_bf16_f32 v138, v132, v133
    v_cvt_pk_bf16_f32 v139, v134, v135
    v_mfma_f32_32x32x16_bf16 v[32:47], a[124:127], v[92:95], v[32:47]
    ds_read_b128 v[76:79], v4 offset:33504
    buffer_load_dwordx4 v177, s[20:23], s84 offen offset:3072 lds
    buffer_store_dwordx4 v[136:139], v2, s[36:39], s76 offen sc1
    v_mfma_f32_32x32x16_bf16 v[16:31], v[152:155], v[156:159], 0
    s_waitcnt lgkmcnt(4)
    v_mfma_f32_32x32x16_bf16 v[16:31], a[0:3], v[48:51], v[16:31]
    ds_read_b128 v[80:83], v4 offset:33536
    s_add_u32 m0, s82, 33280
    s_bfe_u32 s84, s53, 262168
    s_lshl_b32 s84, s84, 15
    s_add_u32 s84, s84, s83
    buffer_load_dwordx4 v174, s[20:23], s84 offen offset:0 lds
    v_mfma_f32_32x32x16_bf16 v[16:31], a[4:7], v[52:55], v[16:31]
    ds_read_b128 v[84:87], v4 offset:33568
    v_mul_f32 v144, v118, v118
    v_mul_f32 v144, 0x3c0a3963, v144
    v_mul_f32 v128, v32, v32
    v_mul_f32 v129, v33, v33
    v_mul_f32 v130, v34, v34
    v_mfma_f32_32x32x16_bf16 v[16:31], a[8:11], v[56:59], v[16:31]
    ds_read_b128 v[88:91], v4 offset:33600
    buffer_load_dwordx4 v175, s[20:23], s84 offen offset:1024 lds
    v_mul_f32 v131, v35, v35
    v_mul_f32 v132, v36, v36
    v_mul_f32 v133, v37, v37
    v_mfma_f32_32x32x16_bf16 v[16:31], a[12:15], v[60:63], v[16:31]
    ds_read_b128 v[92:95], v4 offset:33632
    v_mul_f32 v134, v38, v38
    v_mul_f32 v135, v39, v39
    v_mul_f32 v144, v144, v118
    v_fma_f32 v128, v144, v128, v118
    s_waitcnt lgkmcnt(4)
    v_mfma_f32_32x32x16_bf16 v[16:31], a[16:19], v[64:67], v[16:31]
    ds_read_b128 v[48:51], v4 offset:33664
    buffer_load_dwordx4 v176, s[20:23], s84 offen offset:2048 lds
    v_fma_f32 v129, v144, v129, v118
    v_fma_f32 v130, v144, v130, v118
    v_fma_f32 v131, v144, v131, v118
    v_mfma_f32_32x32x16_bf16 v[16:31], a[20:23], v[68:71], v[16:31]
    ds_read_b128 v[52:55], v4 offset:33696
    v_fma_f32 v132, v144, v132, v118
    v_fma_f32 v133, v144, v133, v118
    v_fma_f32 v134, v144, v134, v118
    v_fma_f32 v135, v144, v135, v118
    v_mul_f32 v128, v32, v128
    v_mfma_f32_32x32x16_bf16 v[16:31], a[24:27], v[72:75], v[16:31]
    ds_read_b128 v[56:59], v4 offset:33728
    buffer_load_dwordx4 v177, s[20:23], s84 offen offset:3072 lds
    v_mul_f32 v129, v33, v129
    v_mul_f32 v130, v34, v130
    v_mul_f32 v131, v35, v131
    v_mfma_f32_32x32x16_bf16 v[16:31], a[28:31], v[76:79], v[16:31]
    ds_read_b128 v[60:63], v4 offset:33760
    v_mul_f32 v132, v36, v132
    v_mul_f32 v133, v37, v133
    v_mul_f32 v134, v38, v134
    s_waitcnt lgkmcnt(4)
    v_mfma_f32_32x32x16_bf16 v[16:31], a[32:35], v[80:83], v[16:31]
    ds_read_b128 v[64:67], v4 offset:33792
    s_add_u32 m0, s82, 49664
    s_bfe_u32 s84, s53, 262172
    s_lshl_b32 s84, s84, 15
    s_add_u32 s84, s84, s83
    buffer_load_dwordx4 v174, s[20:23], s84 offen offset:0 lds
    v_mul_f32 v135, v39, v135
    v_mfma_f32_32x32x16_bf16 v[16:31], a[36:39], v[84:87], v[16:31]
    ds_read_b128 v[68:71], v4 offset:33824
    v_exp_f32 v128, v128
    v_mul_f32 v40, v32, v40
    v_exp_f32 v129, v129
    v_mfma_f32_32x32x16_bf16 v[16:31], a[40:43], v[88:91], v[16:31]
    ds_read_b128 v[72:75], v4 offset:33856
    buffer_load_dwordx4 v175, s[20:23], s84 offen offset:1024 lds
    v_mul_f32 v41, v33, v41
    v_exp_f32 v130, v130
    v_mfma_f32_32x32x16_bf16 v[16:31], a[44:47], v[92:95], v[16:31]
    ds_read_b128 v[76:79], v4 offset:33888
    v_mul_f32 v42, v34, v42
    v_exp_f32 v131, v131
    s_waitcnt lgkmcnt(4)
    v_mfma_f32_32x32x16_bf16 v[16:31], a[48:51], v[48:51], v[16:31]
    ds_read_b128 v[80:83], v4 offset:33920
    buffer_load_dwordx4 v176, s[20:23], s84 offen offset:2048 lds
    v_mul_f32 v43, v35, v43
    v_exp_f32 v132, v132
    v_mfma_f32_32x32x16_bf16 v[16:31], a[52:55], v[52:55], v[16:31]
    ds_read_b128 v[84:87], v4 offset:33952
    v_mul_f32 v44, v36, v44
    v_exp_f32 v133, v133
    v_mul_f32 v45, v37, v45
    v_exp_f32 v134, v134
    v_mfma_f32_32x32x16_bf16 v[16:31], a[56:59], v[56:59], v[16:31]
    ds_read_b128 v[88:91], v4 offset:33984
    buffer_load_dwordx4 v177, s[20:23], s84 offen offset:3072 lds
    v_mov_b32 v160, v124
    v_mov_b32 v161, v124
    v_mfma_f32_32x32x16_bf16 v[16:31], a[60:63], v[60:63], v[16:31]
    ds_read_b128 v[92:95], v4 offset:34016
    v_mul_f32 v46, v38, v46
    v_exp_f32 v135, v135
    v_mul_f32 v47, v39, v47
    s_waitcnt lgkmcnt(4)
    v_mfma_f32_32x32x16_bf16 v[16:31], a[64:67], v[64:67], v[16:31]
    ds_read_b128 v[48:51], v4 offset:34048
    s_waitcnt vmcnt(13)
    v_cmp_ne_u32 vcc, s40, v183
    s_nop 0
    s_cmp_lg_u64 vcc, 0
    s_cbranch_scc1 L_slow1
L_back1:
    v_cmp_ne_u32 vcc, s40, v182
    s_nop 0
    s_cmp_lg_u64 vcc, 0
    s_cbranch_scc1 L_slow2
L_back2:
    s_lshl_b32 s90, s1, 13
    s_add_u32 s91, s90, 1048576
    buffer_load_dwordx4 v[96:99], v168, s[36:39], s91 offen sc1
    v_mfma_f32_32x32x16_bf16 v[16:31], a[68:71], v[68:71], v[16:31]
    ds_read_b128 v[52:55], v4 offset:34080
    v_fma_f32 v128, v128, v117, v117
    v_fma_f32 v129, v129, v117, v117
    v_rcp_f32 v128, v128
    v_fma_f32 v130, v130, v117, v117
    v_mfma_f32_32x32x16_bf16 v[16:31], a[72:75], v[72:75], v[16:31]
    ds_read_b128 v[56:59], v4 offset:34112
    s_add_u32 s91, s90, 1052672
    buffer_load_dwordx4 v[100:103], v168, s[36:39], s91 offen sc1
    v_rcp_f32 v129, v129
    v_mfma_f32_32x32x16_bf16 v[16:31], a[76:79], v[76:79], v[16:31]
    ds_read_b128 v[60:63], v4 offset:34144
    s_barrier
    s_waitcnt lgkmcnt(4)
    v_mfma_f32_32x32x16_bf16 v[16:31], a[80:83], v[80:83], v[16:31]
    ds_read_b128 v[64:67], v4 offset:34176
    s_add_u32 s91, s90, 3145728
    buffer_load_dwordx4 v[104:107], v169, s[36:39], s91 offen sc1
    s_waitcnt vmcnt(12)
    ds_read_b64_tr_b16 a[128:129], v180 offset:0
    ds_read_b64_tr_b16 a[130:131], v180 offset:512
    v_mfma_f32_32x32x16_bf16 v[16:31], a[84:87], v[84:87], v[16:31]
    ds_read_b128 v[68:71], v4 offset:34208
    ds_read_b64_tr_b16 a[132:133], v181 offset:0
    ds_read_b64_tr_b16 a[134:135], v181 offset:512
    v_fma_f32 v131, v131, v117, v117
    v_rcp_f32 v130, v130
    v_mfma_f32_32x32x16_bf16 v[16:31], a[88:91], v[88:91], v[16:31]
    ds_read_b128 v[72:75], v4 offset:34240
    buffer_load_dwordx4 v[108:111], v169, s[36:39], s91 offen offset:16 sc1
    ds_read_b64_tr_b16 a[136:137], v180 offset:2048
    ds_read_b64_tr_b16 a[138:139], v180 offset:2560
    v_mfma_f32_32x32x16_bf16 v[16:31], a[92:95], v[92:95], v[16:31]
    ds_read_b128 v[76:79], v4 offset:34272
    ds_read_b64_tr_b16 a[140:141], v181 offset:2048
    ds_read_b64_tr_b16 a[142:143], v181 offset:2560
    v_fma_f32 v132, v132, v117, v117
    s_waitcnt lgkmcnt(12)
    v_mfma_f32_32x32x16_bf16 v[16:31], a[96:99], v[48:51], v[16:31]
    ds_read_b128 v[80:83], v3 offset:0
    v_rcp_f32 v131, v131
    v_fma_f32 v133, v133, v117, v117
    v_rcp_f32 v132, v132
    v_mfma_f32_32x32x16_bf16 v[16:31], a[100:103], v[52:55], v[16:31]
    ds_read_b128 v[84:87], v3 offset:32
    s_waitcnt lgkmcnt(2)
    s_mov_b32 m0, s48
    s_bfe_u32 s84, s53, 262164
    s_lshl_b32 s84, s84, 15
    s_add_u32 s84, s84, s83
    buffer_load_dwordx4 v174, s[20:23], s84 offen offset:0 lds
    v_mfma_f32_32x32x16_bf16 v[16:31], a[104:107], v[56:59], v[16:31]
    ds_read_b128 v[88:91], v3 offset:64
    v_fma_f32 v134, v134, v117, v117
    v_rcp_f32 v133, v133
    v_fma_f32 v135, v135, v117, v117
    v_mfma_f32_32x32x16_bf16 v[16:31], a[108:111], v[60:63], v[16:31]
    ds_read_b128 v[92:95], v3 offset:96
    buffer_load_dwordx4 v175, s[20:23], s84 offen offset:1024 lds
    v_rcp_f32 v134, v134
    v_mfma_f32_32x32x16_bf16 v[16:31], a[112:115], v[64:67], v[16:31]
    ds_read_b128 v[48:51], v3 offset:128
    v_rcp_f32 v135, v135
    v_mul_f32 v128, v40, v128
    v_mul_f32 v129, v41, v129
    v_mul_f32 v130, v42, v130
    v_mfma_f32_32x32x16_bf16 v[16:31], a[116:119], v[68:71], v[16:31]
    ds_read_b128 v[52:55], v3 offset:160
    buffer_load_dwordx4 v176, s[20:23], s84 offen offset:2048 lds
    v_mul_f32 v131, v43, v131
    v_mul_f32 v132, v44, v132
    v_mul_f32 v133, v45, v133
    v_mfma_f32_32x32x16_bf16 v[16:31], a[120:123], v[72:75], v[16:31]
    ds_read_b128 v[56:59], v3 offset:192
    v_mul_f32 v134, v46, v134
    v_mul_f32 v135, v47, v135
    v_cvt_pk_bf16_f32 v140, v128, v129
    v_cvt_pk_bf16_f32 v141, v130, v131
    v_cvt_pk_bf16_f32 v142, v132, v133
    v_mfma_f32_32x32x16_bf16 v[16:31], a[124:127], v[76:79], v[16:31]
    ds_read_b128 v[60:63], v3 offset:224
    buffer_load_dwordx4 v177, s[20:23], s84 offen offset:3072 lds
    v_cvt_pk_bf16_f32 v143, v134, v135
    buffer_store_dwordx4 v[140:143], v2, s[36:39], s77 offen sc1
    v_mfma_f32_32x32x16_bf16 v[32:47], v[152:155], v[160:163], 0
    s_waitcnt lgkmcnt(4)
    v_mfma_f32_32x32x16_bf16 v[32:47], a[0:3], v[80:83], v[32:47]
    ds_read_b128 v[64:67], v3 offset:256
    s_add_u32 m0, s82, 66560
    s_bfe_u32 s84, s85, 262144
    s_lshl_b32 s84, s84, 15
    s_add_u32 s84, s84, s83
    buffer_load_dwordx4 v174, s[20:23], s84 offen offset:0 lds
    v_mfma_f32_32x32x16_bf16 v[32:47], a[4:7], v[84:87], v[32:47]
    ds_read_b128 v[68:71], v3 offset:288
    v_mul_f32 v144, v122, v122
    v_mul_f32 v144, 0x3c0a3963, v144
    v_mul_f32 v128, v16, v16
    v_mul_f32 v129, v17, v17
    v_mfma_f32_32x32x16_bf16 v[32:47], a[8:11], v[88:91], v[32:47]
    ds_read_b128 v[72:75], v3 offset:320
    buffer_load_dwordx4 v175, s[20:23], s84 offen offset:1024 lds
    v_mul_f32 v130, v18, v18
    v_mul_f32 v131, v19, v19
    v_mfma_f32_32x32x16_bf16 v[32:47], a[12:15], v[92:95], v[32:47]
    ds_read_b128 v[76:79], v3 offset:352
    v_mul_f32 v132, v20, v20
    v_mul_f32 v133, v21, v21
    v_mul_f32 v134, v22, v22
    s_waitcnt lgkmcnt(4)
    v_mfma_f32_32x32x16_bf16 v[32:47], a[16:19], v[48:51], v[32:47]
    ds_read_b128 v[80:83], v3 offset:384
    v_mul_f32 v135, v23, v23
    v_mul_f32 v144, v144, v122
    v_fma_f32 v128, v144, v128, v122
    v_mfma_f32_32x32x16_bf16 v[32:47], a[20:23], v[52:55], v[32:47]
    ds_read_b128 v[84:87], v3 offset:416
    buffer_load_dwordx4 v176, s[20:23], s84 offen offset:2048 lds
    v_fma_f32 v129, v144, v129, v122
    v_fma_f32 v130, v144, v130, v122
    v_mfma_f32_32x32x16_bf16 v[32:47], a[24:27], v[56:59], v[32:47]
    ds_read_b128 v[88:91], v3 offset:448
    v_fma_f32 v131, v144, v131, v122
    v_fma_f32 v132, v144, v132, v122
    v_fma_f32 v133, v144, v133, v122
    v_fma_f32 v134, v144, v134, v122
    v_mfma_f32_32x32x16_bf16 v[32:47], a[28:31], v[60:63], v[32:47]
    ds_read_b128 v[92:95], v3 offset:480
    buffer_load_dwordx4 v177, s[20:23], s84 offen offset:3072 lds
    v_fma_f32 v135, v144, v135, v122
    s_waitcnt lgkmcnt(4)
    v_mfma_f32_32x32x16_bf16 v[32:47], a[32:35], v[64:67], v[32:47]
    ds_read_b128 v[48:51], v3 offset:512
    v_mul_f32 v128, v16, v128
    v_mul_f32 v129, v17, v129
    v_mul_f32 v130, v18, v130
    v_mul_f32 v131, v19, v131
    v_mfma_f32_32x32x16_bf16 v[32:47], a[36:39], v[68:71], v[32:47]
    ds_read_b128 v[52:55], v3 offset:544
    v_mul_f32 v132, v20, v132
    v_mul_f32 v133, v21, v133
    v_mul_f32 v134, v22, v134
    v_mul_f32 v135, v23, v135
    v_mfma_f32_32x32x16_bf16 v[32:47], a[40:43], v[72:75], v[32:47]
    ds_read_b128 v[56:59], v3 offset:576
    s_add_u32 m0, s82, 82944
    s_bfe_u32 s84, s85, 262148
    s_lshl_b32 s84, s84, 15
    s_add_u32 s84, s84, s83
    buffer_load_dwordx4 v174, s[20:23], s84 offen offset:0 lds
    v_mfma_f32_32x32x16_bf16 v[32:47], a[44:47], v[76:79], v[32:47]
    ds_read_b128 v[60:63], v3 offset:608
    v_exp_f32 v128, v128
    v_mul_f32 v24, v16, v24
    s_waitcnt lgkmcnt(4)
    v_mfma_f32_32x32x16_bf16 v[32:47], a[48:51], v[80:83], v[32:47]
    ds_read_b128 v[64:67], v3 offset:640
    buffer_load_dwordx4 v175, s[20:23], s84 offen offset:1024 lds
    v_exp_f32 v129, v129
    v_mfma_f32_32x32x16_bf16 v[32:47], a[52:55], v[84:87], v[32:47]
    ds_read_b128 v[68:71], v3 offset:672
    v_mul_f32 v25, v17, v25
    v_exp_f32 v130, v130
    v_mfma_f32_32x32x16_bf16 v[32:47], a[56:59], v[88:91], v[32:47]
    ds_read_b128 v[72:75], v3 offset:704
    v_mul_f32 v26, v18, v26
    v_exp_f32 v131, v131
    v_mul_f32 v27, v19, v27
    v_mfma_f32_32x32x16_bf16 v[32:47], a[60:63], v[92:95], v[32:47]
    ds_read_b128 v[76:79], v3 offset:736
    buffer_load_dwordx4 v176, s[20:23], s84 offen offset:2048 lds
    v_exp_f32 v132, v132
    s_waitcnt lgkmcnt(4)
    v_mfma_f32_32x32x16_bf16 v[32:47], a[64:67], v[48:51], v[32:47]
    ds_read_b128 v[80:83], v3 offset:768
    v_mul_f32 v28, v20, v28
    v_exp_f32 v133, v133
    v_mfma_f32_32x32x16_bf16 v[32:47], a[68:71], v[52:55], v[32:47]
    ds_read_b128 v[84:87], v3 offset:800
    buffer_load_dwordx4 v177, s[20:23], s84 offen offset:3072 lds
    v_mul_f32 v29, v21, v29
    v_mfma_f32_32x32x16_bf16 v[32:47], a[72:75], v[56:59], v[32:47]
    ds_read_b128 v[88:91], v3 offset:832
    v_exp_f32 v134, v134
    v_mul_f32 v30, v22, v30
    v_exp_f32 v135, v135
    v_mfma_f32_32x32x16_bf16 v[32:47], a[76:79], v[60:63], v[32:47]
    ds_read_b128 v[92:95], v3 offset:864
    s_barrier
    s_waitcnt lgkmcnt(4)
    v_mfma_f32_32x32x16_bf16 v[32:47], a[80:83], v[64:67], v[32:47]
    ds_read_b128 v[48:51], v3 offset:896
    s_waitcnt vmcnt(9)
    ds_read_b64_tr_b16 a[144:145], v180 offset:0
    ds_read_b64_tr_b16 a[146:147], v180 offset:512
    v_mfma_f32_32x32x16_bf16 v[32:47], a[84:87], v[68:71], v[32:47]
    ds_read_b128 v[52:55], v3 offset:928
    buffer_load_dword v13, v187, s[36:39], s46 offen sc1
    ds_read_b64_tr_b16 a[148:149], v181 offset:0
    ds_read_b64_tr_b16 a[150:151], v181 offset:512
    v_mfma_f32_32x32x16_bf16 v[32:47], a[88:91], v[72:75], v[32:47]
    ds_read_b128 v[56:59], v3 offset:960
    ds_read_b64_tr_b16 a[152:153], v180 offset:2048
    ds_read_b64_tr_b16 a[154:155], v180 offset:2560
    v_mul_f32 v31, v23, v31
    v_fma_f32 v128, v128, v121, v121
    v_mfma_f32_32x32x16_bf16 v[32:47], a[92:95], v[76:79], v[32:47]
    ds_read_b128 v[60:63], v3 offset:992
    s_add_u32 m0, s82, 99840
    s_bfe_u32 s84, s85, 262152
    s_lshl_b32 s84, s84, 15
    s_add_u32 s84, s84, s83
    buffer_load_dwordx4 v174, s[20:23], s84 offen offset:0 lds
    ds_read_b64_tr_b16 a[156:157], v181 offset:2048
    ds_read_b64_tr_b16 a[158:159], v181 offset:2560
    s_waitcnt lgkmcnt(12)
    v_mfma_f32_32x32x16_bf16 v[32:47], a[96:99], v[80:83], v[32:47]
    v_fma_f32 v129, v129, v121, v121
    v_rcp_f32 v128, v128
    v_fma_f32 v130, v130, v121, v121
    v_rcp_f32 v129, v129
    v_mfma_f32_32x32x16_bf16 v[32:47], a[100:103], v[84:87], v[32:47]
    buffer_load_dwordx4 v175, s[20:23], s84 offen offset:1024 lds
    v_fma_f32 v131, v131, v121, v121
    v_rcp_f32 v130, v130
    v_mfma_f32_32x32x16_bf16 v[32:47], a[104:107], v[88:91], v[32:47]
    v_fma_f32 v132, v132, v121, v121
    v_rcp_f32 v131, v131
    v_fma_f32 v133, v133, v121, v121
    v_rcp_f32 v132, v132
    v_mfma_f32_32x32x16_bf16 v[32:47], a[108:111], v[92:95], v[32:47]
    buffer_load_dwordx4 v176, s[20:23], s84 offen offset:2048 lds
    v_fma_f32 v134, v134, v121, v121
    s_waitcnt lgkmcnt(2)
    v_mfma_f32_32x32x16_bf16 v[32:47], a[112:115], v[48:51], v[32:47]
    v_rcp_f32 v133, v133
    v_fma_f32 v135, v135, v121, v121
    v_rcp_f32 v134, v134
    v_rcp_f32 v135, v135
    v_mfma_f32_32x32x16_bf16 v[32:47], a[116:119], v[52:55], v[32:47]
    buffer_load_dwordx4 v177, s[20:23], s84 offen offset:3072 lds
    v_mul_f32 v128, v24, v128
    v_mul_f32 v129, v25, v129
    v_mul_f32 v130, v26, v130
    v_mfma_f32_32x32x16_bf16 v[32:47], a[120:123], v[56:59], v[32:47]
    v_mul_f32 v131, v27, v131
    v_mul_f32 v132, v28, v132
    v_mul_f32 v133, v29, v133
    v_mul_f32 v134, v30, v134
    v_mul_f32 v135, v31, v135
    v_mfma_f32_32x32x16_bf16 v[32:47], a[124:127], v[60:63], v[32:47]
    v_cvt_pk_bf16_f32 v136, v128, v129
    v_cvt_pk_bf16_f32 v137, v130, v131
    v_cvt_pk_bf16_f32 v138, v132, v133
    v_cvt_pk_bf16_f32 v139, v134, v135
    buffer_store_dwordx4 v[136:139], v2, s[36:39], s78 offen sc1
    s_waitcnt lgkmcnt(0)
    s_waitcnt vmcnt(14)
    s_barrier
    v_mov_b32 v14, s40
    v_mov_b32 v15, 0
    s_mov_b64 exec, 1
    buffer_store_dword v14, v15, s[36:39], s50 offen sc1
    s_mov_b64 exec, -1
    s_add_u32 s50, s50, 0x8000
    v_mul_f32 v144, v126, v126
    v_pk_mul_f32 v[128:129], v[32:33], v[32:33]
    v_pk_mul_f32 v[130:131], v[34:35], v[34:35]
    v_pk_mul_f32 v[132:133], v[36:37], v[36:37]
    v_pk_mul_f32 v[134:135], v[38:39], v[38:39]
    v_mul_f32 v144, 0x3c0a3963, v144
    v_mul_f32 v144, v144, v126
    v_pk_fma_f32 v[128:129], v[144:145], v[128:129], v[126:127] op_sel_hi:[0,1,0]
    v_pk_fma_f32 v[130:131], v[144:145], v[130:131], v[126:127] op_sel_hi:[0,1,0]
    s_add_u32 m0, s82, 116224
    s_bfe_u32 s84, s85, 262156
    s_lshl_b32 s84, s84, 15
    s_add_u32 s84, s84, s83
    buffer_load_dwordx4 v174, s[20:23], s84 offen offset:0 lds
    v_pk_fma_f32 v[132:133], v[144:145], v[132:133], v[126:127] op_sel_hi:[0,1,0]
    v_pk_fma_f32 v[134:135], v[144:145], v[134:135], v[126:127] op_sel_hi:[0,1,0]
    v_pk_mul_f32 v[128:129], v[32:33], v[128:129]
    v_pk_mul_f32 v[130:131], v[34:35], v[130:131]
    v_pk_mul_f32 v[132:133], v[36:37], v[132:133]
    v_pk_mul_f32 v[134:135], v[38:39], v[134:135]
    v_exp_f32 v128, v128
    v_exp_f32 v129, v129
    v_pk_mul_f32 v[40:41], v[32:33], v[40:41]
    v_exp_f32 v130, v130
    v_exp_f32 v131, v131
    v_pk_mul_f32 v[42:43], v[34:35], v[42:43]
    buffer_load_dwordx4 v175, s[20:23], s84 offen offset:1024 lds
    v_exp_f32 v132, v132
    v_exp_f32 v133, v133
    v_pk_mul_f32 v[44:45], v[36:37], v[44:45]
    v_exp_f32 v134, v134
    v_exp_f32 v135, v135
    v_pk_mul_f32 v[46:47], v[38:39], v[46:47]
    v_pk_fma_f32 v[128:129], v[128:129], v[124:125], v[124:125] op_sel:[0,1,1]
    v_pk_fma_f32 v[130:131], v[130:131], v[124:125], v[124:125] op_sel:[0,1,1]
    v_pk_fma_f32 v[132:133], v[132:133], v[124:125], v[124:125] op_sel:[0,1,1]
    v_pk_fma_f32 v[134:135], v[134:135], v[124:125], v[124:125] op_sel:[0,1,1]
    v_rcp_f32 v128, v128
    buffer_load_dwordx4 v176, s[20:23], s84 offen offset:2048 lds
    v_rcp_f32 v129, v129
    v_rcp_f32 v130, v130
    v_rcp_f32 v131, v131
    v_rcp_f32 v132, v132
    v_rcp_f32 v133, v133
    v_rcp_f32 v134, v134
    v_rcp_f32 v135, v135
    v_pk_mul_f32 v[128:129], v[40:41], v[128:129]
    v_pk_mul_f32 v[130:131], v[42:43], v[130:131]
    buffer_load_dwordx4 v177, s[20:23], s84 offen offset:3072 lds
    v_pk_mul_f32 v[132:133], v[44:45], v[132:133]
    v_pk_mul_f32 v[134:135], v[46:47], v[134:135]
    v_cvt_pk_bf16_f32 v140, v128, v129
    v_cvt_pk_bf16_f32 v141, v130, v131
    v_cvt_pk_bf16_f32 v142, v132, v133
    v_cvt_pk_bf16_f32 v143, v134, v135
    buffer_store_dwordx4 v[140:143], v2, s[36:39], s79 offen sc1
L_join:
    s_add_u32 s56, s1, 1
    s_lshr_b32 s56, s56, 8
    s_sub_u32 s56, s56, 1
    v_and_b32 v100, s56, v100
    v_and_b32 v101, s56, v101
    v_and_b32 v102, s56, v102
    v_and_b32 v103, s56, v103
    v_mfma_f32_16x16x32_bf16 v[32:35], v[96:99], a[176:179], 0
    v_accvgpr_read_b32 v48, a224
    v_accvgpr_read_b32 v49, a225
    v_mfma_f32_16x16x32_bf16 v[40:43], v[100:103], a[176:179], 0
    v_accvgpr_read_b32 v50, a226
    v_accvgpr_read_b32 v51, a227
    v_mfma_f32_16x16x32_bf16 v[36:39], v[96:99], a[180:183], 0
    v_accvgpr_read_b32 v52, a228
    v_accvgpr_read_b32 v53, a229
    v_mfma_f32_16x16x32_bf16 v[44:47], v[100:103], a[180:183], 0
    v_accvgpr_read_b32 v54, a230
    v_accvgpr_read_b32 v55, a231
    v_mfma_f32_16x16x32_bf16 v[32:35], v[100:103], a[184:187], v[32:35]
    v_accvgpr_read_b32 v56, a232
    v_accvgpr_read_b32 v57, a233
    v_mfma_f32_16x16x32_bf16 v[40:43], v[96:99], a[192:195], v[40:43]
    v_accvgpr_read_b32 v58, a234
    v_accvgpr_read_b32 v59, a235
    v_mfma_f32_16x16x32_bf16 v[36:39], v[100:103], a[188:191], v[36:39]
    v_accvgpr_read_b32 v60, a236
    v_accvgpr_read_b32 v61, a237
    v_mfma_f32_16x16x32_bf16 v[44:47], v[96:99], a[196:199], v[44:47]
    v_accvgpr_read_b32 v62, a238
    v_accvgpr_read_b32 v63, a239
    s_waitcnt vmcnt(11)
    v_cmp_ne_u32 vcc, s40, v13
    s_nop 0
    s_cmp_lg_u64 vcc, 0
    s_cbranch_scc1 L_slow6
L_back6:
    s_bfe_u32 s89, s53, 262152
    s_lshl_b32 s89, s89, 11
    s_add_u32 s88, s89, s86
    s_add_u32 s89, s89, s87
    buffer_load_dwordx4 a[64:67], v2, s[36:39], s88 offen offset:0 sc1
    v_fmamk_f32 v24, v188, 0x00000000, v189
    v_fmamk_f32 v25, v188, 0x3f800000, v189
    v_fmamk_f32 v26, v188, 0x40000000, v189
    v_fmamk_f32 v27, v188, 0x40400000, v189
    v_cos_f32 v28, v24
    v_pk_mul_f32 v[88:89], v[32:33], v[48:49]
    v_pk_mul_f32 v[96:97], v[40:41], v[48:49]
    v_pk_mul_f32 v[90:91], v[34:35], v[50:51]
    v_pk_mul_f32 v[98:99], v[42:43], v[50:51]
    v_pk_mul_f32 v[92:93], v[36:37], v[52:53]
    v_pk_mul_f32 v[100:101], v[44:45], v[52:53]
    v_pk_mul_f32 v[94:95], v[38:39], v[54:55]
    v_pk_mul_f32 v[102:103], v[46:47], v[54:55]
    v_pk_fma_f32 v[88:89], v[40:41], v[56:57], v[88:89]
    v_pk_fma_f32 v[96:97], v[32:33], v[56:57], v[96:97] neg_lo:[1,0,0] neg_hi:[1,0,0]
    v_pk_fma_f32 v[90:91], v[42:43], v[58:59], v[90:91]
    v_pk_fma_f32 v[98:99], v[34:35], v[58:59], v[98:99] neg_lo:[1,0,0] neg_hi:[1,0,0]
    v_pk_fma_f32 v[92:93], v[44:45], v[60:61], v[92:93]
    v_pk_fma_f32 v[100:101], v[36:37], v[60:61], v[100:101] neg_lo:[1,0,0] neg_hi:[1,0,0]
    v_pk_fma_f32 v[94:95], v[46:47], v[62:63], v[94:95]
    v_pk_fma_f32 v[102:103], v[38:39], v[62:63], v[102:103] neg_lo:[1,0,0] neg_hi:[1,0,0]
    buffer_load_dwordx4 a[68:71], v2, s[36:39], s89 offen offset:0 sc1
    v_cvt_pk_bf16_f32 v80, v88, v89
    v_cvt_pk_bf16_f32 v81, v90, v91
    v_cvt_pk_bf16_f32 v82, v92, v93
    v_cvt_pk_bf16_f32 v83, v94, v95
    v_cvt_pk_bf16_f32 v84, v96, v97
    v_cvt_pk_bf16_f32 v85, v98, v99
    v_cvt_pk_bf16_f32 v86, v100, v101
    v_cvt_pk_bf16_f32 v87, v102, v103
    ds_write_b64 v170, v[80:81] offset:0
    ds_write_b64 v170, v[82:83] offset:2048
    ds_write_b64 v170, v[84:85] offset:4096
    ds_write_b64 v170, v[86:87] offset:6144
    v_lshlrev_b32 v120, 16, v104
    v_and_b32 v121, 0xffff0000, v104
    v_lshlrev_b32 v16, 16, v108
    v_and_b32 v17, 0xffff0000, v108
    v_lshlrev_b32 v122, 16, v105
    v_and_b32 v123, 0xffff0000, v105
    v_lshlrev_b32 v18, 16, v109
    v_and_b32 v19, 0xffff0000, v109
    v_lshlrev_b32 v124, 16, v106
    v_and_b32 v125, 0xffff0000, v106
    v_lshlrev_b32 v20, 16, v110
    v_and_b32 v21, 0xffff0000, v110
    v_lshlrev_b32 v126, 16, v107
    v_and_b32 v127, 0xffff0000, v107
    v_lshlrev_b32 v22, 16, v111
    v_and_b32 v23, 0xffff0000, v111
    buffer_load_dwordx4 a[72:75], v2, s[36:39], s88 offen offset:1024 sc1
    v_accvgpr_read_b32 v64, a240
    v_accvgpr_read_b32 v65, a241
    v_accvgpr_read_b32 v66, a242
    v_accvgpr_read_b32 v67, a243
    v_accvgpr_read_b32 v68, a244
    v_accvgpr_read_b32 v69, a245
    v_accvgpr_read_b32 v70, a246
    v_accvgpr_read_b32 v71, a247
    v_accvgpr_read_b32 v72, a248
    v_accvgpr_read_b32 v73, a249
    v_accvgpr_read_b32 v74, a250
    v_accvgpr_read_b32 v75, a251
    v_accvgpr_read_b32 v76, a252
    v_accvgpr_read_b32 v77, a253
    v_accvgpr_read_b32 v78, a254
    v_accvgpr_read_b32 v79, a255
    buffer_load_dwordx4 a[76:79], v2, s[36:39], s89 offen offset:1024 sc1
    s_bfe_u32 s89, s53, 262156
    s_lshl_b32 s89, s89, 11
    s_add_u32 s88, s89, s86
    s_add_u32 s89, s89, s87
    buffer_load_dwordx4 a[80:83], v2, s[36:39], s88 offen offset:0 sc1
    s_waitcnt lgkmcnt(0)
    s_barrier
    ds_read_b128 v[88:91], v171 offset:0
    ds_read_b128 v[92:95], v171 offset:4096
    ds_read_b128 v[96:99], v171 offset:2048
    ds_read_b128 v[100:103], v171 offset:6144
    ds_read_b128 v[104:107], v184 offset:0
    ds_read_b128 v[108:111], v184 offset:4096
    ds_read_b128 v[112:115], v184 offset:2048
    ds_read_b128 v[116:119], v184 offset:6144
    buffer_load_dwordx4 a[84:87], v2, s[36:39], s89 offen offset:0 sc1
    buffer_load_dwordx4 a[88:91], v2, s[36:39], s88 offen offset:1024 sc1
    v_cos_f32 v29, v25
    v_cos_f32 v30, v26
    v_cos_f32 v31, v27
    v_sin_f32 v24, -v24
    v_sin_f32 v25, -v25
    v_sin_f32 v26, -v26
    v_sin_f32 v27, -v27
    v_cvt_pk_bf16_f32 v128, v28, v24
    v_cvt_pk_bf16_f32 v129, v29, v25
    v_cvt_pk_bf16_f32 v130, v30, v26
    v_cvt_pk_bf16_f32 v131, v31, v27
    v_fmamk_f32 v24, v188, 0x41000000, v189
    v_fmamk_f32 v25, v188, 0x41100000, v189
    v_fmamk_f32 v26, v188, 0x41200000, v189
    v_fmamk_f32 v27, v188, 0x41300000, v189
    v_cos_f32 v28, v24
    ds_read_b64_tr_b16 a[160:161], v178 offset:33280
    ds_read_b64_tr_b16 a[162:163], v178 offset:33792
    ds_read_b64_tr_b16 a[164:165], v179 offset:33280
    ds_read_b64_tr_b16 a[166:167], v179 offset:33792
    ds_read_b64_tr_b16 a[168:169], v178 offset:35328
    ds_read_b64_tr_b16 a[170:171], v178 offset:35840
    ds_read_b64_tr_b16 a[172:173], v179 offset:35328
    ds_read_b64_tr_b16 a[174:175], v179 offset:35840
    ds_read_b64_tr_b16 a[0:1], v178 offset:49664
    ds_read_b64_tr_b16 a[2:3], v178 offset:50176
    ds_read_b64_tr_b16 a[4:5], v179 offset:49664
    ds_read_b64_tr_b16 a[6:7], v179 offset:50176
    ds_read_b64_tr_b16 a[8:9], v178 offset:51712
    ds_read_b64_tr_b16 a[10:11], v178 offset:52224
    ds_read_b64_tr_b16 a[12:13], v179 offset:51712
    ds_read_b64_tr_b16 a[14:15], v179 offset:52224
    s_waitcnt lgkmcnt(15)
    v_mfma_f32_16x16x32_bf16 v[32:35], a[200:203], v[88:91], 0
    buffer_load_dwordx4 a[92:95], v2, s[36:39], s89 offen offset:1024 sc1
    v_cos_f32 v29, v25
    v_mfma_f32_16x16x32_bf16 v[40:43], a[200:203], v[92:95], 0
    v_cos_f32 v30, v26
    v_mfma_f32_16x16x32_bf16 v[36:39], a[200:203], v[96:99], 0
    s_bfe_u32 s89, s53, 262144
    s_lshl_b32 s89, s89, 11
    s_add_u32 s88, s89, s86
    s_add_u32 s89, s89, s87
    buffer_load_dwordx4 a[224:227], v2, s[36:39], s88 offen offset:0 sc1
    v_cos_f32 v31, v27
    v_mfma_f32_16x16x32_bf16 v[44:47], a[200:203], v[100:103], 0
    v_sin_f32 v24, -v24
    v_mfma_f32_16x16x32_bf16 v[32:35], a[208:211], v[92:95], v[32:35]
    buffer_load_dwordx4 a[228:231], v2, s[36:39], s89 offen offset:0 sc1
    v_sin_f32 v25, -v25
    v_mfma_f32_16x16x32_bf16 v[40:43], a[216:219], v[88:91], v[40:43]
    v_sin_f32 v26, -v26
    v_mfma_f32_16x16x32_bf16 v[36:39], a[208:211], v[100:103], v[36:39]
    s_add_u32 s62, s46, 0x8000
    buffer_load_dword v13, v187, s[36:39], s62 offen sc1
    v_sin_f32 v27, -v27
    v_mfma_f32_16x16x32_bf16 v[44:47], a[216:219], v[96:99], v[44:47]
    v_cvt_pk_bf16_f32 v132, v28, v24
    v_cvt_pk_bf16_f32 v133, v29, v25
    v_mfma_f32_16x16x32_bf16 v[32:35], a[204:207], v[104:107], v[32:35]
    buffer_load_dwordx4 a[232:235], v2, s[36:39], s88 offen offset:1024 sc1
    v_cvt_pk_bf16_f32 v134, v30, v26
    v_cvt_pk_bf16_f32 v135, v31, v27
    v_mfma_f32_16x16x32_bf16 v[40:43], a[204:207], v[108:111], v[40:43]
    v_fmamk_f32 v24, v188, 0x41800000, v189
    v_fmamk_f32 v25, v188, 0x41880000, v189
    v_mfma_f32_16x16x32_bf16 v[36:39], a[204:207], v[112:115], v[36:39]
    buffer_load_dwordx4 a[236:239], v2, s[36:39], s89 offen offset:1024 sc1
    v_fmamk_f32 v26, v188, 0x41900000, v189
    v_fmamk_f32 v27, v188, 0x41980000, v189
    v_mfma_f32_16x16x32_bf16 v[44:47], a[204:207], v[116:119], v[44:47]
    v_cos_f32 v28, v24
    v_mfma_f32_16x16x32_bf16 v[32:35], a[212:215], v[108:111], v[32:35]
    s_bfe_u32 s89, s53, 262148
    s_lshl_b32 s89, s89, 11
    s_add_u32 s88, s89, s86
    s_add_u32 s89, s89, s87
    buffer_load_dwordx4 a[240:243], v2, s[36:39], s88 offen offset:0 sc1
    v_cos_f32 v29, v25
    v_mfma_f32_16x16x32_bf16 v[40:43], a[220:223], v[104:107], v[40:43]
    v_cos_f32 v30, v26
    v_mfma_f32_16x16x32_bf16 v[36:39], a[212:215], v[116:119], v[36:39]
    buffer_load_dwordx4 a[244:247], v2, s[36:39], s89 offen offset:0 sc1
    v_cos_f32 v31, v27
    v_mfma_f32_16x16x32_bf16 v[44:47], a[220:223], v[112:115], v[44:47]
    v_sin_f32 v24, -v24
    buffer_load_dwordx4 a[248:251], v2, s[36:39], s88 offen offset:1024 sc1
    v_sin_f32 v25, -v25
    v_sin_f32 v26, -v26
    v_sin_f32 v27, -v27
    v_pk_mul_f32 v[88:89], v[32:33], v[120:121]
    v_pk_mul_f32 v[96:97], v[40:41], v[120:121]
    v_pk_mul_f32 v[90:91], v[34:35], v[122:123]
    v_pk_mul_f32 v[98:99], v[42:43], v[122:123]
    v_pk_mul_f32 v[92:93], v[36:37], v[124:125]
    v_pk_mul_f32 v[100:101], v[44:45], v[124:125]
    v_pk_mul_f32 v[94:95], v[38:39], v[126:127]
    v_pk_mul_f32 v[102:103], v[46:47], v[126:127]
    v_pk_fma_f32 v[88:89], v[40:41], v[16:17], v[88:89] neg_lo:[1,0,0] neg_hi:[1,0,0]
    v_pk_fma_f32 v[96:97], v[32:33], v[16:17], v[96:97]
    v_pk_fma_f32 v[90:91], v[42:43], v[18:19], v[90:91] neg_lo:[1,0,0] neg_hi:[1,0,0]
    v_pk_fma_f32 v[98:99], v[34:35], v[18:19], v[98:99]
    v_pk_fma_f32 v[92:93], v[44:45], v[20:21], v[92:93] neg_lo:[1,0,0] neg_hi:[1,0,0]
    v_pk_fma_f32 v[100:101], v[36:37], v[20:21], v[100:101]
    v_pk_fma_f32 v[94:95], v[46:47], v[22:23], v[94:95] neg_lo:[1,0,0] neg_hi:[1,0,0]
    v_pk_fma_f32 v[102:103], v[38:39], v[22:23], v[102:103]
    buffer_load_dwordx4 a[252:255], v2, s[36:39], s89 offen offset:1024 sc1
    v_cvt_pk_bf16_f32 v80, v88, v89
    v_cvt_pk_bf16_f32 v81, v90, v91
    v_cvt_pk_bf16_f32 v82, v92, v93
    v_cvt_pk_bf16_f32 v83, v94, v95
    v_cvt_pk_bf16_f32 v84, v96, v97
    v_cvt_pk_bf16_f32 v85, v98, v99
    v_cvt_pk_bf16_f32 v86, v100, v101
    v_cvt_pk_bf16_f32 v87, v102, v103
    ds_write_b64 v170, v[80:81] offset:8192
    ds_write_b64 v170, v[82:83] offset:10240
    ds_write_b64 v170, v[84:85] offset:12288
    ds_write_b64 v170, v[86:87] offset:14336
    s_waitcnt lgkmcnt(4)
    s_add_u32 m0, s82, 33280
    s_bfe_u32 s84, s85, 262160
    s_lshl_b32 s84, s84, 15
    s_add_u32 s84, s84, s83
    buffer_load_dwordx4 v174, s[20:23], s84 offen offset:0 lds
    v_cvt_pk_bf16_f32 v136, v28, v24
    v_cvt_pk_bf16_f32 v137, v29, v25
    v_cvt_pk_bf16_f32 v138, v30, v26
    v_cvt_pk_bf16_f32 v139, v31, v27
    v_fmamk_f32 v24, v188, 0x41c00000, v189
    v_fmamk_f32 v25, v188, 0x41c80000, v189
    s_waitcnt vmcnt(18)
    s_waitcnt lgkmcnt(0)
    s_barrier
    ds_read_b128 v[88:91], v171 offset:8192
    ds_read_b128 v[92:95], v171 offset:12288
    ds_read_b128 v[96:99], v171 offset:10240
    ds_read_b128 v[100:103], v171 offset:14336
    ds_read_b128 v[104:107], v184 offset:8192
    ds_read_b128 v[108:111], v184 offset:12288
    ds_read_b128 v[112:115], v184 offset:10240
    ds_read_b128 v[116:119], v184 offset:14336
    buffer_load_dwordx4 v175, s[20:23], s84 offen offset:1024 lds
    buffer_load_dwordx4 v176, s[20:23], s84 offen offset:2048 lds
    v_fmamk_f32 v26, v188, 0x41d00000, v189
    v_fmamk_f32 v27, v188, 0x41d80000, v189
    v_cos_f32 v28, v24
    v_cos_f32 v29, v25
    v_cos_f32 v30, v26
    v_cos_f32 v31, v27
    v_sin_f32 v24, -v24
    v_sin_f32 v25, -v25
    v_sin_f32 v26, -v26
    v_sin_f32 v27, -v27
    v_cvt_pk_bf16_f32 v140, v28, v24
    v_cvt_pk_bf16_f32 v141, v29, v25
    v_cvt_pk_bf16_f32 v142, v30, v26
    v_cvt_pk_bf16_f32 v143, v31, v27
    v_fmamk_f32 v24, v188, 0x42000000, v189
    v_fmamk_f32 v25, v188, 0x42040000, v189
    v_mov_b32 v14, s40
    v_mov_b32 v15, 0
    s_mov_b64 exec, 1
    buffer_store_dword v14, v15, s[36:39], s50 offen sc1
    s_mov_b64 exec, -1
    ds_read_b64_tr_b16 a[16:17], v166 offset:0
    ds_read_b64_tr_b16 a[18:19], v166 offset:512
    ds_read_b64_tr_b16 a[20:21], v167 offset:0
    ds_read_b64_tr_b16 a[22:23], v167 offset:512
    ds_read_b64_tr_b16 a[24:25], v166 offset:2048
    ds_read_b64_tr_b16 a[26:27], v166 offset:2560
    ds_read_b64_tr_b16 a[28:29], v167 offset:2048
    ds_read_b64_tr_b16 a[30:31], v167 offset:2560
    ds_read_b64_tr_b16 a[32:33], v166 offset:16384
    ds_read_b64_tr_b16 a[34:35], v166 offset:16896
    ds_read_b64_tr_b16 a[36:37], v167 offset:16384
    ds_read_b64_tr_b16 a[38:39], v167 offset:16896
    ds_read_b64_tr_b16 a[40:41], v166 offset:18432
    ds_read_b64_tr_b16 a[42:43], v166 offset:18944
    ds_read_b64_tr_b16 a[44:45], v167 offset:18432
    ds_read_b64_tr_b16 a[46:47], v167 offset:18944
    s_waitcnt lgkmcnt(15)
    v_mfma_f32_16x16x32_bf16 v[32:35], v[88:91], a[200:203], 0
    buffer_load_dwordx4 v177, s[20:23], s84 offen offset:3072 lds
    v_fmamk_f32 v26, v188, 0x42080000, v189
    v_fmamk_f32 v27, v188, 0x420c0000, v189
    v_mfma_f32_16x16x32_bf16 v[40:43], v[92:95], a[200:203], 0
    v_cos_f32 v28, v24
    v_mfma_f32_16x16x32_bf16 v[36:39], v[96:99], a[200:203], 0
    s_add_u32 m0, s82, 49664
    s_bfe_u32 s84, s85, 262164
    s_lshl_b32 s84, s84, 15
    s_add_u32 s84, s84, s83
    buffer_load_dwordx4 v174, s[20:23], s84 offen offset:0 lds
    v_cos_f32 v29, v25
    v_mfma_f32_16x16x32_bf16 v[44:47], v[100:103], a[200:203], 0
    v_cos_f32 v30, v26
    v_mfma_f32_16x16x32_bf16 v[32:35], v[92:95], a[216:219], v[32:35]
    buffer_load_dwordx4 v175, s[20:23], s84 offen offset:1024 lds
    v_cos_f32 v31, v27
    v_mfma_f32_16x16x32_bf16 v[40:43], v[88:91], a[208:211], v[40:43]
    v_sin_f32 v24, -v24
    v_mfma_f32_16x16x32_bf16 v[36:39], v[100:103], a[216:219], v[36:39]
    buffer_load_dwordx4 v176, s[20:23], s84 offen offset:2048 lds
    v_sin_f32 v25, -v25
    v_mfma_f32_16x16x32_bf16 v[44:47], v[96:99], a[208:211], v[44:47]
    v_sin_f32 v26, -v26
    v_mfma_f32_16x16x32_bf16 v[32:35], v[104:107], a[204:207], v[32:35]
    buffer_load_dwordx4 v177, s[20:23], s84 offen offset:3072 lds
    v_sin_f32 v27, -v27
    v_mfma_f32_16x16x32_bf16 v[40:43], v[108:111], a[204:207], v[40:43]
    v_cvt_pk_bf16_f32 v144, v28, v24
    v_cvt_pk_bf16_f32 v145, v29, v25
    v_mfma_f32_16x16x32_bf16 v[36:39], v[112:115], a[204:207], v[36:39]
    s_waitcnt vmcnt(15)
    v_cmp_ne_u32 vcc, s40, v13
    s_nop 0
    s_cmp_lg_u64 vcc, 0
    s_cbranch_scc1 L_slow7
L_back7:
    s_bfe_u32 s89, s53, 262160
    s_lshl_b32 s89, s89, 11
    s_add_u32 s88, s89, s86
    s_add_u32 s89, s89, s87
    buffer_load_dwordx4 a[96:99], v2, s[36:39], s88 offen offset:0 sc1
    v_cvt_pk_bf16_f32 v146, v30, v26
    v_cvt_pk_bf16_f32 v147, v31, v27
    v_mfma_f32_16x16x32_bf16 v[44:47], v[116:119], a[204:207], v[44:47]
    v_fmamk_f32 v24, v188, 0x42200000, v189
    v_fmamk_f32 v25, v188, 0x42240000, v189
    v_mfma_f32_16x16x32_bf16 v[32:35], v[108:111], a[220:223], v[32:35]
    buffer_load_dwordx4 a[100:103], v2, s[36:39], s89 offen offset:0 sc1
    v_fmamk_f32 v26, v188, 0x42280000, v189
    v_fmamk_f32 v27, v188, 0x422c0000, v189
    v_mfma_f32_16x16x32_bf16 v[40:43], v[104:107], a[212:215], v[40:43]
    v_cos_f32 v28, v24
    v_mfma_f32_16x16x32_bf16 v[36:39], v[116:119], a[220:223], v[36:39]
    buffer_load_dwordx4 a[104:107], v2, s[36:39], s88 offen offset:1024 sc1
    v_cos_f32 v29, v25
    v_mfma_f32_16x16x32_bf16 v[44:47], v[112:115], a[212:215], v[44:47]
    v_cos_f32 v30, v26
    buffer_load_dwordx4 a[108:111], v2, s[36:39], s89 offen offset:1024 sc1
    v_cos_f32 v31, v27
    v_sin_f32 v24, -v24
    v_sin_f32 v25, -v25
    v_pk_mul_f32 v[88:89], v[32:33], v[64:65]
    v_pk_mul_f32 v[96:97], v[40:41], v[64:65]
    v_pk_mul_f32 v[90:91], v[34:35], v[66:67]
    v_pk_mul_f32 v[98:99], v[42:43], v[66:67]
    v_pk_mul_f32 v[92:93], v[36:37], v[68:69]
    v_pk_mul_f32 v[100:101], v[44:45], v[68:69]
    v_pk_mul_f32 v[94:95], v[38:39], v[70:71]
    v_pk_mul_f32 v[102:103], v[46:47], v[70:71]
    v_pk_fma_f32 v[88:89], v[40:41], v[72:73], v[88:89] neg_lo:[1,0,0] neg_hi:[1,0,0]
    v_pk_fma_f32 v[96:97], v[32:33], v[72:73], v[96:97]
    v_pk_fma_f32 v[90:91], v[42:43], v[74:75], v[90:91] neg_lo:[1,0,0] neg_hi:[1,0,0]
    v_pk_fma_f32 v[98:99], v[34:35], v[74:75], v[98:99]
    v_pk_fma_f32 v[92:93], v[44:45], v[76:77], v[92:93] neg_lo:[1,0,0] neg_hi:[1,0,0]
    v_pk_fma_f32 v[100:101], v[36:37], v[76:77], v[100:101]
    v_pk_fma_f32 v[94:95], v[46:47], v[78:79], v[94:95] neg_lo:[1,0,0] neg_hi:[1,0,0]
    v_pk_fma_f32 v[102:103], v[38:39], v[78:79], v[102:103]
    s_bfe_u32 s89, s53, 262164
    s_lshl_b32 s89, s89, 11
    s_add_u32 s88, s89, s86
    s_add_u32 s89, s89, s87
    buffer_load_dwordx4 a[112:115], v2, s[36:39], s88 offen offset:0 sc1
    v_cvt_pk_bf16_f32 v80, v88, v89
    v_cvt_pk_bf16_f32 v81, v90, v91
    v_cvt_pk_bf16_f32 v82, v92, v93
    v_cvt_pk_bf16_f32 v83, v94, v95
    v_cvt_pk_bf16_f32 v84, v96, v97
    v_cvt_pk_bf16_f32 v85, v98, v99
    v_cvt_pk_bf16_f32 v86, v100, v101
    v_cvt_pk_bf16_f32 v87, v102, v103
    v_mfma_f32_16x16x32_bf16 v[32:35], a[176:179], v[80:83], 0
    buffer_load_dwordx4 a[116:119], v2, s[36:39], s89 offen offset:0 sc1
    v_sin_f32 v26, -v26
    v_mfma_f32_16x16x32_bf16 v[40:43], a[176:179], v[84:87], 0
    v_sin_f32 v27, -v27
    v_mfma_f32_16x16x32_bf16 v[36:39], a[180:183], v[80:83], 0
    buffer_load_dwordx4 a[120:123], v2, s[36:39], s88 offen offset:1024 sc1
    v_cvt_pk_bf16_f32 v148, v28, v24
    v_cvt_pk_bf16_f32 v149, v29, v25
    v_mfma_f32_16x16x32_bf16 v[44:47], a[180:183], v[84:87], 0
    v_cvt_pk_bf16_f32 v150, v30, v26
    v_cvt_pk_bf16_f32 v151, v31, v27
    v_mfma_f32_16x16x32_bf16 v[32:35], a[192:195], v[84:87], v[32:35]
    buffer_load_dwordx4 a[124:127], v2, s[36:39], s89 offen offset:1024 sc1
    v_fmamk_f32 v24, v188, 0x42400000, v189
    v_fmamk_f32 v25, v188, 0x42440000, v189
    v_mfma_f32_16x16x32_bf16 v[40:43], a[184:187], v[80:83], v[40:43]
    v_fmamk_f32 v26, v188, 0x42480000, v189
    v_fmamk_f32 v27, v188, 0x424c0000, v189
    v_mfma_f32_16x16x32_bf16 v[36:39], a[196:199], v[84:87], v[36:39]
    v_cos_f32 v28, v24
    v_mfma_f32_16x16x32_bf16 v[44:47], a[188:191], v[80:83], v[44:47]
    v_cos_f32 v29, v25
    s_lshl_b32 s56, s44, 13
    s_add_u32 s57, s56, 5242880
    s_add_u32 s58, s56, 5246976
    v_cos_f32 v30, v26
    v_cos_f32 v31, v27
    v_cvt_pk_bf16_f32 v80, v32, v33
    v_cvt_pk_bf16_f32 v81, v34, v35
    v_cvt_pk_bf16_f32 v82, v36, v37
    v_cvt_pk_bf16_f32 v83, v38, v39
    v_cvt_pk_bf16_f32 v84, v40, v41
    v_cvt_pk_bf16_f32 v85, v42, v43
    v_cvt_pk_bf16_f32 v86, v44, v45
    v_cvt_pk_bf16_f32 v87, v46, v47
    buffer_store_dwordx4 v[80:83], v168, s[36:39], s57 offen sc1
    v_xor_b32 v84, s43, v84
    v_xor_b32 v85, s43, v85
    v_xor_b32 v86, s43, v86
    v_xor_b32 v87, s43, v87
    buffer_store_dwordx4 v[84:87], v168, s[36:39], s58 offen sc1
    v_sin_f32 v24, -v24
    v_sin_f32 v25, -v25
    v_sin_f32 v26, -v26
    v_sin_f32 v27, -v27
    v_cvt_pk_bf16_f32 v152, v28, v24
    v_cvt_pk_bf16_f32 v153, v29, v25
    v_cvt_pk_bf16_f32 v154, v30, v26
    v_cvt_pk_bf16_f32 v155, v31, v27
    v_mfma_f32_32x32x16_bf16 v[16:31], v[192:195], a[224:227], 0
    buffer_load_dwordx4 v[88:91], v186, s[8:11], s45 offen
    v_mfma_f32_32x32x16_bf16 v[32:47], v[196:199], a[224:227], 0
    ds_read_b64_tr_b16 a[48:49], v166 offset:33280
    ds_read_b64_tr_b16 a[50:51], v166 offset:33792
    v_mfma_f32_32x32x16_bf16 v[48:63], v[192:195], a[228:231], 0
    ds_read_b64_tr_b16 a[52:53], v167 offset:33280
    ds_read_b64_tr_b16 a[54:55], v167 offset:33792
    v_fmamk_f32 v96, v188, 0x42600000, v189
    v_fmamk_f32 v97, v188, 0x42640000, v189
    v_mfma_f32_32x32x16_bf16 v[64:79], v[196:199], a[228:231], 0
    buffer_load_dwordx4 v[92:95], v186, s[8:11], s47 offen
    ds_read_b64_tr_b16 a[56:57], v166 offset:35328
    ds_read_b64_tr_b16 a[58:59], v166 offset:35840
    v_fmamk_f32 v98, v188, 0x42680000, v189
    s_waitcnt vmcnt(26)
    v_mfma_f32_32x32x16_bf16 v[16:31], v[200:203], a[232:235], v[16:31]
    ds_read_b64_tr_b16 a[60:61], v167 offset:35328
    ds_read_b64_tr_b16 a[62:63], v167 offset:35840
    v_fmamk_f32 v99, v188, 0x426c0000, v189
    v_cos_f32 v100, v96
    v_mfma_f32_32x32x16_bf16 v[32:47], v[204:207], a[232:235], v[32:47]
    v_cos_f32 v101, v97
    v_cos_f32 v102, v98
    s_waitcnt vmcnt(25)
    v_mfma_f32_32x32x16_bf16 v[48:63], v[200:203], a[236:239], v[48:63]
    v_cos_f32 v103, v99
    v_sin_f32 v96, -v96
    v_mfma_f32_32x32x16_bf16 v[64:79], v[204:207], a[236:239], v[64:79]
    s_bfe_u32 s89, s53, 262168
    s_lshl_b32 s89, s89, 11
    s_add_u32 s88, s89, s86
    s_add_u32 s89, s89, s87
    buffer_load_dwordx4 v[192:195], v2, s[36:39], s88 offen offset:0 sc1
    ds_read_b64_tr_b16 a[176:177], v166 offset:49664
    ds_read_b64_tr_b16 a[178:179], v166 offset:50176
    s_waitcnt vmcnt(25)
    v_mfma_f32_32x32x16_bf16 v[16:31], v[208:211], a[240:243], v[16:31]
    ds_read_b64_tr_b16 a[180:181], v167 offset:49664
    ds_read_b64_tr_b16 a[182:183], v167 offset:50176
    v_sin_f32 v97, -v97
    v_sin_f32 v98, -v98
    v_mfma_f32_32x32x16_bf16 v[32:47], v[212:215], a[240:243], v[32:47]
    buffer_load_dwordx4 v[196:199], v2, s[36:39], s89 offen offset:0 sc1
    ds_read_b64_tr_b16 a[184:185], v166 offset:51712
    ds_read_b64_tr_b16 a[186:187], v166 offset:52224
    s_waitcnt vmcnt(25)
    v_mfma_f32_32x32x16_bf16 v[48:63], v[208:211], a[244:247], v[48:63]
    ds_read_b64_tr_b16 a[188:189], v167 offset:51712
    ds_read_b64_tr_b16 a[190:191], v167 offset:52224
    v_sin_f32 v99, -v99
    v_mfma_f32_32x32x16_bf16 v[64:79], v[212:215], a[244:247], v[64:79]
    buffer_load_dwordx4 v[200:203], v2, s[36:39], s88 offen offset:1024 sc1
    v_cvt_pk_bf16_f32 v156, v100, v96
    v_cvt_pk_bf16_f32 v157, v101, v97
    v_cvt_pk_bf16_f32 v158, v102, v98
    s_waitcnt vmcnt(25)
    v_mfma_f32_32x32x16_bf16 v[16:31], v[216:219], a[248:251], v[16:31]
    v_cvt_pk_bf16_f32 v159, v103, v99
    v_fmamk_f32 v96, v188, 0x42800000, v189
    v_fmamk_f32 v97, v188, 0x42820000, v189
    v_fmamk_f32 v98, v188, 0x42840000, v189
    v_mfma_f32_32x32x16_bf16 v[32:47], v[220:223], a[248:251], v[32:47]
    buffer_load_dwordx4 v[204:207], v2, s[36:39], s89 offen offset:1024 sc1
    s_waitcnt vmcnt(20)
    ds_read_b64_tr_b16 a[192:193], v178 offset:33280
    ds_read_b64_tr_b16 a[194:195], v178 offset:33792
    v_mfma_f32_32x32x16_bf16 v[48:63], v[216:219], a[252:255], v[48:63]
    ds_read_b64_tr_b16 a[196:197], v179 offset:33280
    ds_read_b64_tr_b16 a[198:199], v179 offset:33792
    v_fmamk_f32 v99, v188, 0x42860000, v189
    v_cos_f32 v100, v96
    v_mfma_f32_32x32x16_bf16 v[64:79], v[220:223], a[252:255], v[64:79]
    s_bfe_u32 s89, s53, 262172
    s_lshl_b32 s89, s89, 11
    s_add_u32 s88, s89, s86
    s_add_u32 s89, s89, s87
    buffer_load_dwordx4 v[208:211], v2, s[36:39], s88 offen offset:0 sc1
    ds_read_b64_tr_b16 a[200:201], v178 offset:35328
    ds_read_b64_tr_b16 a[202:203], v178 offset:35840
    v_mfma_f32_32x32x16_bf16 v[16:31], v[224:227], a[64:67], v[16:31]
    buffer_load_dwordx4 v[212:215], v2, s[36:39], s89 offen offset:0 sc1
    ds_read_b64_tr_b16 a[204:205], v179 offset:35328
    ds_read_b64_tr_b16 a[206:207], v179 offset:35840
    v_mfma_f32_32x32x16_bf16 v[32:47], v[228:231], a[64:67], v[32:47]
    buffer_load_dwordx4 v[216:219], v2, s[36:39], s88 offen offset:1024 sc1
    v_cos_f32 v101, v97
    v_mfma_f32_32x32x16_bf16 v[48:63], v[224:227], a[68:71], v[48:63]
    v_cos_f32 v102, v98
    v_cos_f32 v103, v99
    v_sin_f32 v96, -v96
    v_mfma_f32_32x32x16_bf16 v[64:79], v[228:231], a[68:71], v[64:79]
    buffer_load_dwordx4 v[220:223], v2, s[36:39], s89 offen offset:1024 sc1
    s_waitcnt vmcnt(20)
    ds_read_b64_tr_b16 a[208:209], v178 offset:49664
    ds_read_b64_tr_b16 a[210:211], v178 offset:50176
    v_mfma_f32_32x32x16_bf16 v[16:31], v[232:235], a[72:75], v[16:31]
    s_add_u32 s62, s46, 0x10000
    buffer_load_dword v13, v187, s[36:39], s62 offen sc1
    ds_read_b64_tr_b16 a[212:213], v179 offset:49664
    ds_read_b64_tr_b16 a[214:215], v179 offset:50176
    v_mfma_f32_32x32x16_bf16 v[32:47], v[236:239], a[72:75], v[32:47]
    s_lshl_b32 s56, s3, 15
    s_lshl_b32 s57, s44, 4
    s_add_u32 s56, s56, s57
    s_add_u32 s56, s56, 393216
    s_waitcnt vmcnt(11)
    v_mov_b32 v14, s40
    v_mov_b32 v15, 0
    s_mov_b64 exec, 1
    buffer_store_dword v14, v15, s[36:39], s56 offen sc1
    s_mov_b64 exec, -1
    ds_read_b64_tr_b16 a[216:217], v178 offset:51712
    ds_read_b64_tr_b16 a[218:219], v178 offset:52224
    s_nop 1
    v_mfma_f32_32x32x16_bf16 v[48:63], v[232:235], a[76:79], v[48:63]
    ds_read_b64_tr_b16 a[220:221], v179 offset:51712
    ds_read_b64_tr_b16 a[222:223], v179 offset:52224
    v_sin_f32 v97, -v97
    v_mfma_f32_32x32x16_bf16 v[64:79], v[236:239], a[76:79], v[64:79]
    s_bfe_u32 s89, s85, 262144
    s_lshl_b32 s89, s89, 11
    s_add_u32 s88, s89, s86
    s_add_u32 s89, s89, s87
    buffer_load_dwordx4 v[224:227], v2, s[36:39], s88 offen offset:0 sc1
    v_mfma_f32_32x32x16_bf16 v[16:31], v[240:243], a[80:83], v[16:31]
    v_sin_f32 v98, -v98
    v_sin_f32 v99, -v99
    v_cvt_pk_bf16_f32 v160, v100, v96
    v_mfma_f32_32x32x16_bf16 v[32:47], v[244:247], a[80:83], v[32:47]
    buffer_load_dwordx4 v[228:231], v2, s[36:39], s89 offen offset:0 sc1
    v_cvt_pk_bf16_f32 v161, v101, v97
    v_cvt_pk_bf16_f32 v162, v102, v98
    v_cvt_pk_bf16_f32 v163, v103, v99
    v_mfma_f32_32x32x16_bf16 v[48:63], v[240:243], a[84:87], v[48:63]
    v_fmamk_f32 v96, v188, 0x42900000, v189
    v_fmamk_f32 v97, v188, 0x42920000, v189
    v_fmamk_f32 v98, v188, 0x42940000, v189
    v_fmamk_f32 v99, v188, 0x42960000, v189
    v_mfma_f32_32x32x16_bf16 v[64:79], v[244:247], a[84:87], v[64:79]
    buffer_load_dwordx4 v[232:235], v2, s[36:39], s88 offen offset:1024 sc1
    v_cos_f32 v100, v96
    v_cos_f32 v101, v97
    v_mfma_f32_32x32x16_bf16 v[16:31], v[248:251], a[88:91], v[16:31]
    v_cos_f32 v102, v98
    v_cos_f32 v103, v99
    v_mfma_f32_32x32x16_bf16 v[32:47], v[252:255], a[88:91], v[32:47]
    buffer_load_dwordx4 v[236:239], v2, s[36:39], s89 offen offset:1024 sc1
    v_sin_f32 v96, -v96
    v_mfma_f32_32x32x16_bf16 v[48:63], v[248:251], a[92:95], v[48:63]
    v_sin_f32 v97, -v97
    v_sin_f32 v98, -v98
    v_sin_f32 v99, -v99
    v_mfma_f32_32x32x16_bf16 v[64:79], v[252:255], a[92:95], v[64:79]
    s_bfe_u32 s89, s85, 262148
    s_lshl_b32 s89, s89, 11
    s_add_u32 s88, s89, s86
    s_add_u32 s89, s89, s87
    buffer_load_dwordx4 v[240:243], v2, s[36:39], s88 offen offset:0 sc1
    v_mfma_f32_32x32x16_bf16 v[16:31], a[128:131], a[96:99], v[16:31]
    v_cvt_pk_bf16_f32 v112, v100, v96
    v_cvt_pk_bf16_f32 v113, v101, v97
    v_cvt_pk_bf16_f32 v114, v102, v98
    v_cvt_pk_bf16_f32 v115, v103, v99
    v_fmamk_f32 v96, v188, 0x42a00000, v189
    v_mfma_f32_32x32x16_bf16 v[32:47], a[132:135], a[96:99], v[32:47]
    buffer_load_dwordx4 v[244:247], v2, s[36:39], s89 offen offset:0 sc1
    v_fmamk_f32 v97, v188, 0x42a20000, v189
    v_fmamk_f32 v98, v188, 0x42a40000, v189
    v_fmamk_f32 v99, v188, 0x42a60000, v189
    v_mfma_f32_32x32x16_bf16 v[48:63], a[128:131], a[100:103], v[48:63]
    v_lshrrev_b32 v12, 3, v1
    v_cos_f32 v100, v96
    v_cos_f32 v101, v97
    v_mfma_f32_32x32x16_bf16 v[64:79], a[132:135], a[100:103], v[64:79]
    buffer_load_dwordx4 v[248:251], v2, s[36:39], s88 offen offset:1024 sc1
    v_cos_f32 v102, v98
    v_mfma_f32_32x32x16_bf16 v[16:31], a[136:139], a[104:107], v[16:31]
    v_and_b32 v11, 7, v1
    v_and_b32 v9, 2, v12
    v_cos_f32 v103, v99
    v_mfma_f32_32x32x16_bf16 v[32:47], a[140:143], a[104:107], v[32:47]
    buffer_load_dwordx4 v[252:255], v2, s[36:39], s89 offen offset:1024 sc1
    v_sin_f32 v96, -v96
    v_sin_f32 v97, -v97
    v_mfma_f32_32x32x16_bf16 v[48:63], a[136:139], a[108:111], v[48:63]
    v_lshlrev_b32 v9, 1, v9
    v_sin_f32 v98, -v98
    v_sin_f32 v99, -v99
    v_mfma_f32_32x32x16_bf16 v[64:79], a[140:143], a[108:111], v[64:79]
    s_waitcnt vmcnt(9)
    v_cmp_ne_u32 vcc, s40, v13
    s_nop 0
    s_cmp_lg_u64 vcc, 0
    s_cbranch_scc1 L_slow8
L_back8:
    s_bfe_u32 s89, s85, 262152
    s_lshl_b32 s89, s89, 11
    s_add_u32 s88, s89, s86
    s_add_u32 s89, s89, s87
    buffer_load_dwordx4 a[128:131], v2, s[36:39], s88 offen offset:0 sc1
    v_mfma_f32_32x32x16_bf16 v[16:31], a[144:147], a[112:115], v[16:31]
    v_xor_b32 v11, v11, v9
    v_cvt_pk_bf16_f32 v116, v100, v96
    v_cvt_pk_bf16_f32 v117, v101, v97
    v_cvt_pk_bf16_f32 v118, v102, v98
    v_mfma_f32_32x32x16_bf16 v[32:47], a[148:151], a[112:115], v[32:47]
    buffer_load_dwordx4 a[132:135], v2, s[36:39], s89 offen offset:0 sc1
    v_cvt_pk_bf16_f32 v119, v103, v99
    v_fmamk_f32 v96, v188, 0x42b00000, v189
    v_fmamk_f32 v97, v188, 0x42b20000, v189
    v_mfma_f32_32x32x16_bf16 v[48:63], a[144:147], a[116:119], v[48:63]
    v_lshlrev_b32 v11, 4, v11
    v_fmamk_f32 v98, v188, 0x42b40000, v189
    v_fmamk_f32 v99, v188, 0x42b60000, v189
    v_cos_f32 v100, v96
    v_mfma_f32_32x32x16_bf16 v[64:79], a[148:151], a[116:119], v[64:79]
    buffer_load_dwordx4 a[136:139], v2, s[36:39], s88 offen offset:1024 sc1
    v_cos_f32 v101, v97
    v_mfma_f32_32x32x16_bf16 v[16:31], a[152:155], a[120:123], v[16:31]
    v_lshl_add_u32 v9, v12, 12, v11
    v_lshlrev_b32 v11, 4, v1
    v_cos_f32 v102, v98
    v_cos_f32 v103, v99
    v_mfma_f32_32x32x16_bf16 v[32:47], a[156:159], a[120:123], v[32:47]
    buffer_load_dwordx4 a[140:143], v2, s[36:39], s89 offen offset:1024 sc1
    v_sin_f32 v96, -v96
    v_mfma_f32_32x32x16_bf16 v[48:63], a[152:155], a[124:127], v[48:63]
    s_lshr_b32 s91, s51, 4
    v_sin_f32 v97, -v97
    v_sin_f32 v98, -v98
    v_mfma_f32_32x32x16_bf16 v[64:79], a[156:159], a[124:127], v[64:79]
    s_bfe_u32 s89, s85, 262156
    s_lshl_b32 s89, s89, 11
    s_add_u32 s88, s89, s86
    s_add_u32 s89, s89, s87
    buffer_load_dwordx4 a[144:147], v2, s[36:39], s88 offen offset:0 sc1
    v_mfma_f32_32x32x16_bf16 v[16:31], a[160:163], v[192:195], v[16:31]
    s_lshl_b32 s91, s91, 15
    s_lshl_b32 s92, s3, 10
    v_sin_f32 v99, -v99
    v_cvt_pk_bf16_f32 v120, v100, v96
    v_cvt_pk_bf16_f32 v121, v101, v97
    v_mfma_f32_32x32x16_bf16 v[32:47], a[164:167], v[192:195], v[32:47]
    buffer_load_dwordx4 a[148:151], v2, s[36:39], s89 offen offset:0 sc1
    v_cvt_pk_bf16_f32 v122, v102, v98
    v_cvt_pk_bf16_f32 v123, v103, v99
    v_fmamk_f32 v96, v188, 0x42c00000, v189
    v_mfma_f32_32x32x16_bf16 v[48:63], a[160:163], v[196:199], v[48:63]
    s_add_u32 s91, s91, s92
    s_add_u32 s80, s91, 393216
    s_lshl_b32 s91, s3, 19
    v_fmamk_f32 v97, v188, 0x42c20000, v189
    v_fmamk_f32 v98, v188, 0x42c40000, v189
    v_fmamk_f32 v99, v188, 0x42c60000, v189
    v_mfma_f32_32x32x16_bf16 v[64:79], a[164:167], v[196:199], v[64:79]
    buffer_load_dwordx4 a[152:155], v2, s[36:39], s88 offen offset:1024 sc1
    v_cos_f32 v100, v96
    v_mfma_f32_32x32x16_bf16 v[16:31], a[168:171], v[200:203], v[16:31]
    s_lshl_b32 s92, s51, 6
    s_add_u32 s91, s91, s92
    v_cos_f32 v101, v97
    v_cos_f32 v102, v98
    v_mfma_f32_32x32x16_bf16 v[32:47], a[172:175], v[200:203], v[32:47]
    buffer_load_dwordx4 a[156:159], v2, s[36:39], s89 offen offset:1024 sc1
    v_cos_f32 v103, v99
    v_sin_f32 v96, -v96
    v_mfma_f32_32x32x16_bf16 v[48:63], a[168:171], v[204:207], v[48:63]
    s_add_u32 s81, s91, 5242880
    s_lshr_b32 s90, s52, 1
    v_sin_f32 v97, -v97
    v_mfma_f32_32x32x16_bf16 v[64:79], a[172:175], v[204:207], v[64:79]
    s_bfe_u32 s89, s85, 262160
    s_lshl_b32 s89, s89, 11
    s_add_u32 s88, s89, s86
    s_add_u32 s89, s89, s87
    buffer_load_dwordx4 a[160:163], v2, s[36:39], s88 offen offset:0 sc1
    v_sin_f32 v98, -v98
    v_mfma_f32_32x32x16_bf16 v[16:31], a[0:3], v[208:211], v[16:31]
    s_add_u32 s92, s82, 33280
    v_sin_f32 v99, -v99
    v_cvt_pk_bf16_f32 v124, v100, v96
    v_mfma_f32_32x32x16_bf16 v[32:47], a[4:7], v[208:211], v[32:47]
    buffer_load_dwordx4 a[164:167], v2, s[36:39], s89 offen offset:0 sc1
    v_cvt_pk_bf16_f32 v125, v101, v97
    v_cvt_pk_bf16_f32 v126, v102, v98
    v_cvt_pk_bf16_f32 v127, v103, v99
    v_mfma_f32_32x32x16_bf16 v[48:63], a[0:3], v[212:215], v[48:63]
    v_add_u32 v174, 31744, v9
    v_add_u32 v175, 63488, v9
    v_fmamk_f32 v96, v188, 0x42d00000, v189
    v_fmamk_f32 v97, v188, 0x42d20000, v189
    v_mfma_f32_32x32x16_bf16 v[64:79], a[4:7], v[212:215], v[64:79]
    buffer_load_dwordx4 a[168:171], v2, s[36:39], s88 offen offset:1024 sc1
    v_fmamk_f32 v98, v188, 0x42d40000, v189
    v_fmamk_f32 v99, v188, 0x42d60000, v189
    v_mfma_f32_32x32x16_bf16 v[16:31], a[8:11], v[216:219], v[16:31]
    v_add_u32 v176, 95232, v9
    v_cos_f32 v100, v96
    v_cos_f32 v101, v97
    v_mfma_f32_32x32x16_bf16 v[32:47], a[12:15], v[216:219], v[32:47]
    buffer_load_dwordx4 a[172:175], v2, s[36:39], s89 offen offset:1024 sc1
    v_cos_f32 v102, v98
    v_mfma_f32_32x32x16_bf16 v[48:63], a[8:11], v[220:223], v[48:63]
    v_and_b32 v12, 1, v1
    v_lshlrev_b32 v12, 2, v12
    v_cos_f32 v103, v99
    v_mfma_f32_32x32x16_bf16 v[64:79], a[12:15], v[220:223], v[64:79]
    s_bfe_u32 s89, s85, 262164
    s_lshl_b32 s89, s89, 11
    s_add_u32 s88, s89, s86
    s_add_u32 s89, s89, s87
    buffer_load_dwordx4 a[0:3], v2, s[36:39], s88 offen offset:0 sc1
    s_waitcnt vmcnt(20) lgkmcnt(15)
    v_mfma_f32_32x32x16_bf16 v[16:31], a[16:19], v[224:227], v[16:31]
    buffer_load_dwordx4 a[4:7], v2, s[36:39], s89 offen offset:0 sc1
    v_sin_f32 v96, -v96
    v_mfma_f32_32x32x16_bf16 v[32:47], a[20:23], v[224:227], v[32:47]
    v_bfe_u32 v4, v1, 4, 1
    v_sin_f32 v97, -v97
    s_waitcnt vmcnt(20)
    v_mfma_f32_32x32x16_bf16 v[48:63], a[16:19], v[228:231], v[48:63]
    buffer_load_dwordx4 a[8:11], v2, s[36:39], s88 offen offset:1024 sc1
    v_sin_f32 v98, -v98
    v_mfma_f32_32x32x16_bf16 v[64:79], a[20:23], v[228:231], v[64:79]
    buffer_load_dwordx4 a[12:15], v2, s[36:39], s89 offen offset:1024 sc1
    v_sin_f32 v99, -v99
    s_waitcnt vmcnt(21)
    v_mfma_f32_32x32x16_bf16 v[16:31], a[24:27], v[232:235], v[16:31]
    v_lshl_or_b32 v12, v4, 1, v12
    v_cvt_pk_bf16_f32 v192, v100, v96
    v_cvt_pk_bf16_f32 v193, v101, v97
    v_cvt_pk_bf16_f32 v194, v102, v98
    v_mfma_f32_32x32x16_bf16 v[32:47], a[28:31], v[232:235], v[32:47]
    buffer_load_dword v14, v11, s[36:39], s80 offen sc1
    v_cvt_pk_bf16_f32 v195, v103, v99
    v_fmamk_f32 v96, v188, 0x42e00000, v189
    v_fmamk_f32 v97, v188, 0x42e20000, v189
    s_waitcnt vmcnt(21)
    v_mfma_f32_32x32x16_bf16 v[48:63], a[24:27], v[236:239], v[48:63]
    v_bfe_u32 v4, v1, 1, 1
    v_or_b32 v12, v12, v4
    v_fmamk_f32 v98, v188, 0x42e40000, v189
    v_fmamk_f32 v99, v188, 0x42e60000, v189
    v_mfma_f32_32x32x16_bf16 v[64:79], a[28:31], v[236:239], v[64:79]
    v_lshlrev_b32 v12, 3, v12
    v_cos_f32 v100, v96
    s_waitcnt vmcnt(20)
    v_mfma_f32_32x32x16_bf16 v[16:31], a[32:35], v[240:243], v[16:31]
    v_bfe_u32 v4, v1, 3, 1
    v_lshl_or_b32 v12, v4, 6, v12
    v_cos_f32 v101, v97
    v_mfma_f32_32x32x16_bf16 v[32:47], a[36:39], v[240:243], v[32:47]
    v_bfe_u32 v4, v1, 2, 2
    v_cos_f32 v102, v98
    v_cos_f32 v103, v99
    s_waitcnt vmcnt(19)
    v_mfma_f32_32x32x16_bf16 v[48:63], a[32:35], v[244:247], v[48:63]
    v_lshl_or_b32 v12, v4, 7, v12
    v_sin_f32 v96, -v96
    v_mfma_f32_32x32x16_bf16 v[64:79], a[36:39], v[244:247], v[64:79]
    v_lshrrev_b32 v4, 5, v1
    v_lshl_or_b32 v12, v4, 10, v12
    v_sin_f32 v97, -v97
    s_waitcnt vmcnt(18)
    v_mfma_f32_32x32x16_bf16 v[16:31], a[40:43], v[248:251], v[16:31]
    s_lshr_b32 s91, s3, 1
    s_lshl_b32 s91, s91, 6
    v_sin_f32 v98, -v98
    v_sin_f32 v99, -v99
    v_mfma_f32_32x32x16_bf16 v[32:47], a[44:47], v[248:251], v[32:47]
    v_xor_b32 v3, s91, v12
    v_cvt_pk_bf16_f32 v196, v100, v96
    v_cvt_pk_bf16_f32 v197, v101, v97
    v_cvt_pk_bf16_f32 v198, v102, v98
    s_waitcnt vmcnt(17)
    v_mfma_f32_32x32x16_bf16 v[48:63], a[40:43], v[252:255], v[48:63]
    v_add_u32 v3, 33280, v3
    v_add_u32 v4, 33280, v3
    v_cvt_pk_bf16_f32 v199, v103, v99
    v_fmamk_f32 v96, v188, 0x42f00000, v189
    v_lshlrev_b32 v224, 16, v88
    v_mfma_f32_32x32x16_bf16 v[64:79], a[44:47], v[252:255], v[64:79]
    v_add_u32 v8, s82, v2
    v_fmamk_f32 v97, v188, 0x42f20000, v189
    v_fmamk_f32 v98, v188, 0x42f40000, v189
    v_fmamk_f32 v99, v188, 0x42f60000, v189
    s_waitcnt vmcnt(16)
    v_mfma_f32_32x32x16_bf16 v[16:31], a[48:51], a[128:131], v[16:31]
    v_add_u32 v177, 99840, v8
    v_cos_f32 v100, v96
    v_and_b32 v225, 0xffff0000, v88
    v_lshlrev_b32 v226, 16, v89
    v_mfma_f32_32x32x16_bf16 v[32:47], a[52:55], a[128:131], v[32:47]
    s_xor_b32 s91, s3, 1
    s_lshl_b32 s91, s91, 12
    s_add_u32 s91, s91, 99840
    v_cos_f32 v101, v97
    v_cos_f32 v102, v98
    s_waitcnt vmcnt(15)
    v_mfma_f32_32x32x16_bf16 v[48:63], a[48:51], a[132:135], v[48:63]
    v_add_u32 v5, s91, v2
    v_cos_f32 v103, v99
    v_and_b32 v227, 0xffff0000, v89
    v_mfma_f32_32x32x16_bf16 v[64:79], a[52:55], a[132:135], v[64:79]
    s_xor_b32 s91, s3, 2
    s_lshl_b32 s91, s91, 12
    s_add_u32 s91, s91, 116224
    v_sin_f32 v96, -v96
    v_lshlrev_b32 v228, 16, v90
    s_waitcnt vmcnt(14)
    v_mfma_f32_32x32x16_bf16 v[16:31], a[56:59], a[136:139], v[16:31]
    v_add_u32 v6, s91, v2
    v_sin_f32 v97, -v97
    v_sin_f32 v98, -v98
    v_mfma_f32_32x32x16_bf16 v[32:47], a[60:63], a[136:139], v[32:47]
    s_xor_b32 s91, s3, 3
    s_lshl_b32 s91, s91, 12
    v_sin_f32 v99, -v99
    v_and_b32 v229, 0xffff0000, v90
    s_waitcnt vmcnt(13)
    v_mfma_f32_32x32x16_bf16 v[48:63], a[56:59], a[140:143], v[48:63]
    s_add_u32 s91, s91, 0
    v_add_u32 v7, s91, v2
    v_cvt_pk_bf16_f32 v200, v100, v96
    v_cvt_pk_bf16_f32 v201, v101, v97
    v_cvt_pk_bf16_f32 v202, v102, v98
    v_mfma_f32_32x32x16_bf16 v[64:79], a[60:63], a[140:143], v[64:79]
    s_waitcnt vmcnt(0)
    v_cmp_ne_u32 vcc, s40, v14
    s_nop 0
    s_cmp_lg_u64 vcc, 0
    s_cbranch_scc1 L_slow9
L_back9:
    s_waitcnt lgkmcnt(0)
    s_add_u32 s58, s90, 0
    s_and_b32 s58, s58, 3
    s_lshl_b32 s57, s58, 17
    s_add_u32 s57, s81, s57
    s_mul_i32 s58, s58, 16640
    s_and_b32 s58, s58, 4294966784
    s_add_u32 m0, s92, s58
    s_nop 0
    buffer_load_dwordx4 v9, s[36:39], s57 offen offset:0 sc1 lds
    v_mfma_f32_32x32x16_bf16 v[16:31], a[176:179], a[144:147], v[16:31]
    buffer_load_dwordx4 v174, s[36:39], s57 offen offset:1024 sc1 lds
    v_cvt_pk_bf16_f32 v203, v103, v99
    v_mul_f32 v96, 0x43000000, v188
    v_mfma_f32_32x32x16_bf16 v[32:47], a[180:183], a[144:147], v[32:47]
    buffer_load_dwordx4 v175, s[36:39], s57 offen offset:2048 sc1 lds
    v_mul_f32 v97, 0xc1f80000, v189
    v_add_f32 v96, v96, v97
    v_lshlrev_b32 v230, 16, v91
    v_mfma_f32_32x32x16_bf16 v[48:63], a[176:179], a[148:151], v[48:63]
    buffer_load_dwordx4 v176, s[36:39], s57 offen offset:3072 sc1 lds
    v_mov_b32 v205, v129
    v_and_b32 v231, 0xffff0000, v91
    v_mfma_f32_32x32x16_bf16 v[64:79], a[180:183], a[148:151], v[64:79]
    s_add_u32 s58, s90, 1
    s_and_b32 s58, s58, 3
    s_lshl_b32 s57, s58, 17
    s_add_u32 s57, s81, s57
    s_mul_i32 s58, s58, 16640
    s_and_b32 s58, s58, 4294966784
    s_add_u32 m0, s92, s58
    s_nop 0
    buffer_load_dwordx4 v9, s[36:39], s57 offen offset:0 sc1 lds
    v_mfma_f32_32x32x16_bf16 v[16:31], a[184:187], a[152:155], v[16:31]
    buffer_load_dwordx4 v174, s[36:39], s57 offen offset:1024 sc1 lds
    v_cos_f32 v97, v96
    v_mfma_f32_32x32x16_bf16 v[32:47], a[188:191], a[152:155], v[32:47]
    buffer_load_dwordx4 v175, s[36:39], s57 offen offset:2048 sc1 lds
    v_sin_f32 v96, -v96
    v_mov_b32 v206, v130
    v_mfma_f32_32x32x16_bf16 v[48:63], a[184:187], a[156:159], v[48:63]
    buffer_load_dwordx4 v176, s[36:39], s57 offen offset:3072 sc1 lds
    v_mov_b32 v207, v131
    v_cvt_pk_bf16_f32 v204, v97, v96
    v_lshlrev_b32 v232, 16, v92
    v_mfma_f32_32x32x16_bf16 v[64:79], a[188:191], a[156:159], v[64:79]
    s_add_u32 s58, s90, 2
    s_and_b32 s58, s58, 3
    s_lshl_b32 s57, s58, 17
    s_add_u32 s57, s81, s57
    s_mul_i32 s58, s58, 16640
    s_and_b32 s58, s58, 4294966784
    s_add_u32 m0, s92, s58
    s_nop 0
    buffer_load_dwordx4 v9, s[36:39], s57 offen offset:0 sc1 lds
    v_mfma_f32_32x32x16_bf16 v[64:79], a[196:199], a[164:167], v[64:79]
    buffer_load_dwordx4 v174, s[36:39], s57 offen offset:1024 sc1 lds
    v_and_b32 v233, 0xffff0000, v92
    v_lshlrev_b32 v234, 16, v93
    v_mfma_f32_32x32x16_bf16 v[64:79], a[204:207], a[172:175], v[64:79]
    buffer_load_dwordx4 v175, s[36:39], s57 offen offset:2048 sc1 lds
    v_and_b32 v235, 0xffff0000, v93
    v_lshlrev_b32 v236, 16, v94
    v_and_b32 v237, 0xffff0000, v94
    v_mfma_f32_32x32x16_bf16 v[64:79], a[212:215], a[4:7], v[64:79]
    buffer_load_dwordx4 v176, s[36:39], s57 offen offset:3072 sc1 lds
    v_lshlrev_b32 v238, 16, v95
    v_and_b32 v239, 0xffff0000, v95
    v_mfma_f32_32x32x16_bf16 v[64:79], a[220:223], a[12:15], v[64:79]
    s_add_u32 s58, s90, 3
    s_and_b32 s58, s58, 3
    s_lshl_b32 s57, s58, 17
    s_add_u32 s57, s81, s57
    s_mul_i32 s58, s58, 16640
    s_and_b32 s58, s58, 4294966784
    s_add_u32 m0, s92, s58
    s_nop 0
    buffer_load_dwordx4 v9, s[36:39], s57 offen offset:0 sc1 lds
    v_mfma_f32_32x32x16_bf16 v[48:63], a[192:195], a[164:167], v[48:63]
    buffer_load_dwordx4 v174, s[36:39], s57 offen offset:1024 sc1 lds
    v_mfma_f32_32x32x16_bf16 v[48:63], a[200:203], a[172:175], v[48:63]
    buffer_load_dwordx4 v175, s[36:39], s57 offen offset:2048 sc1 lds
    v_mfma_f32_32x32x16_bf16 v[48:63], a[208:211], a[4:7], v[48:63]
    buffer_load_dwordx4 v176, s[36:39], s57 offen offset:3072 sc1 lds
    ds_write_b128 v8, v[64:67] offset:0
    v_mfma_f32_32x32x16_bf16 v[48:63], a[216:219], a[12:15], v[48:63]
    ds_write_b128 v8, v[68:71] offset:1024
    v_mfma_f32_32x32x16_bf16 v[32:47], a[196:199], a[160:163], v[32:47]
    ds_write_b128 v8, v[72:75] offset:2048
    v_mfma_f32_32x32x16_bf16 v[32:47], a[204:207], a[168:171], v[32:47]
    ds_write_b128 v8, v[76:79] offset:3072
    v_mfma_f32_32x32x16_bf16 v[32:47], a[212:215], a[0:3], v[32:47]
    s_nop 5
    ds_write_b128 v177, v[48:51] offset:16384
    v_mfma_f32_32x32x16_bf16 v[32:47], a[220:223], a[8:11], v[32:47]
    ds_write_b128 v177, v[52:55] offset:17408
    v_mfma_f32_32x32x16_bf16 v[16:31], a[192:195], a[160:163], v[16:31]
    ds_write_b128 v177, v[56:59] offset:18432
    v_mfma_f32_32x32x16_bf16 v[16:31], a[200:203], a[168:171], v[16:31]
    ds_write_b128 v177, v[60:63] offset:19456
    v_mfma_f32_32x32x16_bf16 v[16:31], a[208:211], a[0:3], v[16:31]
    v_mfma_f32_32x32x16_bf16 v[16:31], a[216:219], a[8:11], v[16:31]
    s_nop 4
    ds_write_b128 v177, v[32:35] offset:0
    ds_write_b128 v177, v[36:39] offset:1024
    ds_write_b128 v177, v[40:43] offset:2048
    ds_write_b128 v177, v[44:47] offset:3072
    v_and_b32 v10, 31, v1
    v_mul_u32_u24 v10, 80, v10
    v_lshrrev_b32 v11, 5, v1
    v_lshl_add_u32 v10, v11, 5, v10
    v_add_u32 v10, s48, v10
    v_lshrrev_b32 v11, 2, v1
    v_mul_u32_u24 v11, 80, v11
    v_and_b32 v12, 3, v1
    v_lshl_add_u32 v11, v12, 4, v11
    v_add_u32 v11, s48, v11
    s_mov_b32 s90, 0xbfb8aa3b
    s_mov_b32 s91, 0xbfb8aa3b
    s_waitcnt lgkmcnt(0)
    s_barrier
    ds_read_b128 v[64:67], v7 offset:0
    ds_read_b128 v[68:71], v7 offset:1024
    ds_read_b128 v[72:75], v7 offset:2048
    ds_read_b128 v[76:79], v7 offset:3072
    ds_read_b128 v[48:51], v6 offset:0
    ds_read_b128 v[52:55], v6 offset:1024
    ds_read_b128 v[56:59], v6 offset:2048
    ds_read_b128 v[60:63], v6 offset:3072
    ds_read_b128 v[32:35], v5 offset:0
    ds_read_b128 v[36:39], v5 offset:1024
    ds_read_b128 v[40:43], v5 offset:2048
    ds_read_b128 v[44:47], v5 offset:3072
    s_waitcnt lgkmcnt(11)
    v_pk_add_f32 v[16:17], v[16:17], v[64:65]
    v_pk_add_f32 v[18:19], v[18:19], v[66:67]
    s_waitcnt lgkmcnt(10)
    v_pk_add_f32 v[20:21], v[20:21], v[68:69]
    v_pk_add_f32 v[22:23], v[22:23], v[70:71]
    s_waitcnt lgkmcnt(9)
    v_pk_add_f32 v[24:25], v[24:25], v[72:73]
    v_pk_add_f32 v[26:27], v[26:27], v[74:75]
    s_waitcnt lgkmcnt(8)
    v_pk_add_f32 v[28:29], v[28:29], v[76:77]
    v_pk_add_f32 v[30:31], v[30:31], v[78:79]
    s_waitcnt lgkmcnt(7)
    v_pk_add_f32 v[16:17], v[16:17], v[48:49]
    v_pk_add_f32 v[18:19], v[18:19], v[50:51]
    s_waitcnt lgkmcnt(6)
    v_pk_add_f32 v[20:21], v[20:21], v[52:53]
    v_pk_add_f32 v[22:23], v[22:23], v[54:55]
    s_waitcnt lgkmcnt(5)
    v_pk_add_f32 v[24:25], v[24:25], v[56:57]
    v_pk_add_f32 v[26:27], v[26:27], v[58:59]
    s_waitcnt lgkmcnt(4)
    v_pk_add_f32 v[28:29], v[28:29], v[60:61]
    v_pk_add_f32 v[30:31], v[30:31], v[62:63]
    s_waitcnt lgkmcnt(3)
    v_pk_add_f32 v[16:17], v[16:17], v[32:33]
    v_pk_add_f32 v[18:19], v[18:19], v[34:35]
    s_waitcnt lgkmcnt(2)
    v_pk_add_f32 v[20:21], v[20:21], v[36:37]
    v_pk_add_f32 v[22:23], v[22:23], v[38:39]
    s_waitcnt lgkmcnt(1)
    v_pk_add_f32 v[24:25], v[24:25], v[40:41]
    v_pk_add_f32 v[26:27], v[26:27], v[42:43]
    s_waitcnt lgkmcnt(0)
    v_pk_add_f32 v[28:29], v[28:29], v[44:45]
    v_pk_add_f32 v[30:31], v[30:31], v[46:47]
    v_pk_mul_f32 v[32:33], v[16:17], s[90:91]
    v_pk_mul_f32 v[34:35], v[18:19], s[90:91]
    v_pk_mul_f32 v[36:37], v[20:21], s[90:91]
    v_pk_mul_f32 v[38:39], v[22:23], s[90:91]
    v_pk_mul_f32 v[40:41], v[24:25], s[90:91]
    v_pk_mul_f32 v[42:43], v[26:27], s[90:91]
    v_pk_mul_f32 v[44:45], v[28:29], s[90:91]
    v_pk_mul_f32 v[46:47], v[30:31], s[90:91]
    s_waitcnt vmcnt(0)
    s_barrier
    ds_read_b64_tr_b16 a[64:65], v3 offset:0
    ds_read_b64_tr_b16 a[66:67], v3 offset:512
    ds_read_b64_tr_b16 a[128:129], v3 offset:8192
    ds_read_b64_tr_b16 a[130:131], v3 offset:8704
    ds_read_b64_tr_b16 a[68:69], v3 offset:2048
    ds_read_b64_tr_b16 a[70:71], v3 offset:2560
    ds_read_b64_tr_b16 a[132:133], v3 offset:10240
    ds_read_b64_tr_b16 a[134:135], v3 offset:10752
    ds_read_b64_tr_b16 a[72:73], v3 offset:16384
    ds_read_b64_tr_b16 a[74:75], v3 offset:16896
    ds_read_b64_tr_b16 a[136:137], v3 offset:24576
    ds_read_b64_tr_b16 a[138:139], v3 offset:25088
    ds_read_b64_tr_b16 a[76:77], v3 offset:18432
    ds_read_b64_tr_b16 a[78:79], v3 offset:18944
    s_or_b32 s56, s2, s3
    s_cmp_lg_u32 s56, 0
    s_cbranch_scc1 L_noep
    s_mov_b32 s56, 0
    v_mov_b32 v12, s40
    v_mov_b32 v13, 0
    s_mov_b64 exec, 1
    buffer_store_dword v12, v13, s[36:39], s56 offen sc1
    s_mov_b64 exec, -1
L_noep:
    s_waitcnt lgkmcnt(6)
    s_nop 2
    v_mfma_f32_32x32x16_bf16 v[80:95], v[204:207], a[64:67], 0
    ds_read_b64_tr_b16 a[140:141], v3 offset:26624
    ds_read_b64_tr_b16 a[142:143], v3 offset:27136
    v_mfma_f32_32x32x16_bf16 v[96:111], v[128:131], a[128:131], 0
    ds_read_b64_tr_b16 a[80:81], v4 offset:0
    ds_read_b64_tr_b16 a[82:83], v4 offset:512
    v_exp_f32 v32, v32
    v_mfma_f32_32x32x16_bf16 v[80:95], v[132:135], a[68:71], v[80:95]
    ds_read_b64_tr_b16 a[144:145], v4 offset:8192
    ds_read_b64_tr_b16 a[146:147], v4 offset:8704
    v_exp_f32 v33, v33
    v_exp_f32 v34, v34
    v_mfma_f32_32x32x16_bf16 v[96:111], v[132:135], a[132:135], v[96:111]
    ds_read_b64_tr_b16 a[84:85], v4 offset:2048
    ds_read_b64_tr_b16 a[86:87], v4 offset:2560
    v_exp_f32 v35, v35
    s_waitcnt lgkmcnt(6)
    v_mfma_f32_32x32x16_bf16 v[80:95], v[136:139], a[72:75], v[80:95]
    ds_read_b64_tr_b16 a[148:149], v4 offset:10240
    ds_read_b64_tr_b16 a[150:151], v4 offset:10752
    v_exp_f32 v36, v36
    v_mfma_f32_32x32x16_bf16 v[96:111], v[136:139], a[136:139], v[96:111]
    ds_read_b64_tr_b16 a[88:89], v4 offset:16384
    ds_read_b64_tr_b16 a[90:91], v4 offset:16896
    v_exp_f32 v37, v37
    v_exp_f32 v38, v38
    v_mfma_f32_32x32x16_bf16 v[80:95], v[140:143], a[76:79], v[80:95]
    ds_read_b64_tr_b16 a[152:153], v4 offset:24576
    ds_read_b64_tr_b16 a[154:155], v4 offset:25088
    v_exp_f32 v39, v39
    v_mfma_f32_32x32x16_bf16 v[96:111], v[140:143], a[140:143], v[96:111]
    ds_read_b64_tr_b16 a[92:93], v4 offset:18432
    ds_read_b64_tr_b16 a[94:95], v4 offset:18944
    v_exp_f32 v40, v40
    s_waitcnt lgkmcnt(6)
    v_mfma_f32_32x32x16_bf16 v[80:95], v[144:147], a[80:83], v[80:95]
    ds_read_b64_tr_b16 a[156:157], v4 offset:26624
    ds_read_b64_tr_b16 a[158:159], v4 offset:27136
    v_exp_f32 v41, v41
    v_exp_f32 v42, v42
    v_mfma_f32_32x32x16_bf16 v[96:111], v[144:147], a[144:147], v[96:111]
    ds_read_b64_tr_b16 a[96:97], v3 offset:4096
    ds_read_b64_tr_b16 a[98:99], v3 offset:4608
    v_exp_f32 v43, v43
    v_mfma_f32_32x32x16_bf16 v[80:95], v[148:151], a[84:87], v[80:95]
    ds_read_b64_tr_b16 a[160:161], v3 offset:12288
    ds_read_b64_tr_b16 a[162:163], v3 offset:12800
    v_exp_f32 v44, v44
    v_exp_f32 v45, v45
    v_mfma_f32_32x32x16_bf16 v[96:111], v[148:151], a[148:151], v[96:111]
    ds_read_b64_tr_b16 a[100:101], v3 offset:6144
    ds_read_b64_tr_b16 a[102:103], v3 offset:6656
    v_exp_f32 v46, v46
    s_waitcnt lgkmcnt(6)
    v_mfma_f32_32x32x16_bf16 v[80:95], v[152:155], a[88:91], v[80:95]
    ds_read_b64_tr_b16 a[164:165], v3 offset:14336
    ds_read_b64_tr_b16 a[166:167], v3 offset:14848
    v_exp_f32 v47, v47
    v_mfma_f32_32x32x16_bf16 v[96:111], v[152:155], a[152:155], v[96:111]
    ds_read_b64_tr_b16 a[104:105], v3 offset:20480
    ds_read_b64_tr_b16 a[106:107], v3 offset:20992
    v_add_f32 v32, 1.0, v32
    v_add_f32 v33, 1.0, v33
    v_add_f32 v34, 1.0, v34
    v_mfma_f32_32x32x16_bf16 v[80:95], v[156:159], a[92:95], v[80:95]
    ds_read_b64_tr_b16 a[168:169], v3 offset:28672
    ds_read_b64_tr_b16 a[170:171], v3 offset:29184
    v_add_f32 v35, 1.0, v35
    v_add_f32 v36, 1.0, v36
    v_add_f32 v37, 1.0, v37
    v_mfma_f32_32x32x16_bf16 v[96:111], v[156:159], a[156:159], v[96:111]
    ds_read_b64_tr_b16 a[108:109], v3 offset:22528
    ds_read_b64_tr_b16 a[110:111], v3 offset:23040
    v_add_f32 v38, 1.0, v38
    v_add_f32 v39, 1.0, v39
    s_waitcnt lgkmcnt(6)
    v_mfma_f32_32x32x16_bf16 v[80:95], v[160:163], a[96:99], v[80:95]
    ds_read_b64_tr_b16 a[172:173], v3 offset:30720
    ds_read_b64_tr_b16 a[174:175], v3 offset:31232
    v_add_f32 v40, 1.0, v40
    v_add_f32 v41, 1.0, v41
    v_add_f32 v42, 1.0, v42
    v_mfma_f32_32x32x16_bf16 v[96:111], v[160:163], a[160:163], v[96:111]
    ds_read_b64_tr_b16 a[112:113], v4 offset:4096
    ds_read_b64_tr_b16 a[114:115], v4 offset:4608
    v_add_f32 v43, 1.0, v43
    v_add_f32 v44, 1.0, v44
    v_add_f32 v45, 1.0, v45
    v_mfma_f32_32x32x16_bf16 v[80:95], v[112:115], a[100:103], v[80:95]
    ds_read_b64_tr_b16 a[176:177], v4 offset:12288
    ds_read_b64_tr_b16 a[178:179], v4 offset:12800
    v_add_f32 v46, 1.0, v46
    v_add_f32 v47, 1.0, v47
    v_rcp_f32 v32, v32
    v_mfma_f32_32x32x16_bf16 v[96:111], v[112:115], a[164:167], v[96:111]
    ds_read_b64_tr_b16 a[116:117], v4 offset:6144
    ds_read_b64_tr_b16 a[118:119], v4 offset:6656
    v_rcp_f32 v33, v33
    s_waitcnt lgkmcnt(6)
    v_mfma_f32_32x32x16_bf16 v[80:95], v[116:119], a[104:107], v[80:95]
    ds_read_b64_tr_b16 a[180:181], v4 offset:14336
    ds_read_b64_tr_b16 a[182:183], v4 offset:14848
    v_rcp_f32 v34, v34
    v_mfma_f32_32x32x16_bf16 v[96:111], v[116:119], a[168:171], v[96:111]
    ds_read_b64_tr_b16 a[120:121], v4 offset:20480
    ds_read_b64_tr_b16 a[122:123], v4 offset:20992
    v_rcp_f32 v35, v35
    v_rcp_f32 v36, v36
    v_mfma_f32_32x32x16_bf16 v[80:95], v[120:123], a[108:111], v[80:95]
    ds_read_b64_tr_b16 a[184:185], v4 offset:28672
    ds_read_b64_tr_b16 a[186:187], v4 offset:29184
    v_rcp_f32 v37, v37
    v_mfma_f32_32x32x16_bf16 v[96:111], v[120:123], a[172:175], v[96:111]
    ds_read_b64_tr_b16 a[124:125], v4 offset:22528
    ds_read_b64_tr_b16 a[126:127], v4 offset:23040
    v_rcp_f32 v38, v38
    s_waitcnt lgkmcnt(6)
    v_mfma_f32_32x32x16_bf16 v[80:95], v[124:127], a[112:115], v[80:95]
    ds_read_b64_tr_b16 a[188:189], v4 offset:30720
    ds_read_b64_tr_b16 a[190:191], v4 offset:31232
    v_rcp_f32 v39, v39
    v_mfma_f32_32x32x16_bf16 v[96:111], v[124:127], a[176:179], v[96:111]
    v_rcp_f32 v40, v40
    v_rcp_f32 v41, v41
    v_rcp_f32 v42, v42
    v_mfma_f32_32x32x16_bf16 v[80:95], v[192:195], a[116:119], v[80:95]
    v_rcp_f32 v43, v43
    v_rcp_f32 v44, v44
    v_rcp_f32 v45, v45
    v_mfma_f32_32x32x16_bf16 v[96:111], v[192:195], a[180:183], v[96:111]
    v_rcp_f32 v46, v46
    v_rcp_f32 v47, v47
    s_waitcnt lgkmcnt(0)
    v_mfma_f32_32x32x16_bf16 v[80:95], v[196:199], a[120:123], v[80:95]
    v_mul_f32 v16, v16, v32
    v_mul_f32 v17, v17, v33
    v_mul_f32 v18, v18, v34
    v_mul_f32 v19, v19, v35
    v_mul_f32 v20, v20, v36
    v_mfma_f32_32x32x16_bf16 v[96:111], v[196:199], a[184:187], v[96:111]
    v_mul_f32 v21, v21, v37
    v_mul_f32 v22, v22, v38
    v_mul_f32 v23, v23, v39
    v_mul_f32 v24, v24, v40
    v_mul_f32 v25, v25, v41
    v_mul_f32 v26, v26, v42
    v_mfma_f32_32x32x16_bf16 v[80:95], v[200:203], a[124:127], v[80:95]
    v_mul_f32 v27, v27, v43
    v_mul_f32 v28, v28, v44
    v_mul_f32 v29, v29, v45
    v_mul_f32 v30, v30, v46
    v_mul_f32 v31, v31, v47
    v_mfma_f32_32x32x16_bf16 v[96:111], v[200:203], a[188:191], v[96:111]
    s_nop 11
    v_pk_add_f32 v[80:81], v[80:81], v[96:97] neg_hi:[0,1]
    v_pk_add_f32 v[82:83], v[82:83], v[98:99] neg_hi:[0,1]
    v_pk_add_f32 v[84:85], v[84:85], v[100:101] neg_hi:[0,1]
    v_pk_add_f32 v[86:87], v[86:87], v[102:103] neg_hi:[0,1]
    v_pk_add_f32 v[88:89], v[88:89], v[104:105] neg_hi:[0,1]
    v_pk_add_f32 v[90:91], v[90:91], v[106:107] neg_hi:[0,1]
    v_pk_add_f32 v[92:93], v[92:93], v[108:109] neg_hi:[0,1]
    v_pk_add_f32 v[94:95], v[94:95], v[110:111] neg_hi:[0,1]
    v_pk_mul_f32 v[80:81], v[16:17], v[80:81]
    v_pk_mul_f32 v[82:83], v[18:19], v[82:83]
    v_pk_mul_f32 v[84:85], v[20:21], v[84:85]
    v_pk_mul_f32 v[86:87], v[22:23], v[86:87]
    v_pk_mul_f32 v[88:89], v[24:25], v[88:89]
    v_pk_mul_f32 v[90:91], v[26:27], v[90:91]
    v_pk_mul_f32 v[92:93], v[28:29], v[92:93]
    v_pk_mul_f32 v[94:95], v[30:31], v[94:95]
    v_cvt_pk_bf16_f32 v48, v80, v81
    v_cvt_pk_bf16_f32 v49, v82, v83
    v_cvt_pk_bf16_f32 v50, v84, v85
    v_cvt_pk_bf16_f32 v51, v86, v87
    ds_write_b128 v10, v[48:51]
    v_cvt_pk_bf16_f32 v52, v88, v89
    v_cvt_pk_bf16_f32 v53, v90, v91
    v_cvt_pk_bf16_f32 v54, v92, v93
    v_cvt_pk_bf16_f32 v55, v94, v95
    ds_write_b128 v10, v[52:55] offset:16
    ds_read_b128 v[56:59], v11
    ds_read_b128 v[60:63], v11 offset:1280
    s_waitcnt lgkmcnt(1)
    v_lshlrev_b32 v64, 16, v56
    v_and_b32 v65, 0xffff0000, v56
    v_lshlrev_b32 v66, 16, v57
    v_and_b32 v67, 0xffff0000, v57
    v_lshlrev_b32 v68, 16, v58
    v_and_b32 v69, 0xffff0000, v58
    v_lshlrev_b32 v70, 16, v59
    v_and_b32 v71, 0xffff0000, v59
    v_pk_add_f32 v[64:65], v[64:65], v[224:225]
    v_pk_add_f32 v[66:67], v[66:67], v[226:227]
    v_pk_add_f32 v[68:69], v[68:69], v[228:229]
    v_pk_add_f32 v[70:71], v[70:71], v[230:231]
    v_cvt_pk_bf16_f32 v72, v64, v65
    v_cvt_pk_bf16_f32 v73, v66, v67
    v_cvt_pk_bf16_f32 v74, v68, v69
    v_cvt_pk_bf16_f32 v75, v70, v71
    buffer_store_dwordx4 v[72:75], v186, s[32:35], s45 offen
    s_waitcnt lgkmcnt(0)
    v_lshlrev_b32 v64, 16, v60
    v_and_b32 v65, 0xffff0000, v60
    v_lshlrev_b32 v66, 16, v61
    v_and_b32 v67, 0xffff0000, v61
    v_lshlrev_b32 v68, 16, v62
    v_and_b32 v69, 0xffff0000, v62
    v_lshlrev_b32 v70, 16, v63
    v_and_b32 v71, 0xffff0000, v63
    v_pk_add_f32 v[64:65], v[64:65], v[232:233]
    v_pk_add_f32 v[66:67], v[66:67], v[234:235]
    v_pk_add_f32 v[68:69], v[68:69], v[236:237]
    v_pk_add_f32 v[70:71], v[70:71], v[238:239]
    v_cvt_pk_bf16_f32 v76, v64, v65
    v_cvt_pk_bf16_f32 v77, v66, v67
    v_cvt_pk_bf16_f32 v78, v68, v69
    v_cvt_pk_bf16_f32 v79, v70, v71
    buffer_store_dwordx4 v[76:79], v186, s[32:35], s47 offen
L_end:
    s_endpgm
    s_nop 7
L_dft:
    s_mov_b32 s24, s66
    s_mov_b32 s25, s67
    s_mov_b32 s28, s68
    s_mov_b32 s29, s69
    s_mov_b32 s20, s76
    s_mov_b32 s21, s77
    s_mov_b32 s32, s78
    s_mov_b32 s33, s79
    s_mov_b32 s26, 1052672
    s_mov_b32 s27, 0x20000
    s_mov_b32 s30, 1052672
    s_mov_b32 s31, 0x20000
    s_mov_b32 s22, 1835008
    s_mov_b32 s23, 0x20000
    s_mov_b32 s34, 2097152
    s_mov_b32 s35, 0x20000
    s_mov_b32 s38, 16777216
    s_mov_b32 s39, 0x20000
    s_mov_b32 s54, 400000
    s_mov_b32 s1, s50
    s_lshl_b32 s58, s46, 3
    v_add_u32 v8, s58, v1
    v_and_b32 v8, 63, v8
    v_lshlrev_b32 v8, 4, v8
    v_add_u32 v9, 64496, v8
    v_add_u32 v10, 128992, v8
    v_add_u32 v11, 193488, v8
    s_and_b32 s58, s3, 1
    s_lshl_b32 s58, s58, 20
    s_lshr_b32 s59, s3, 1
    s_lshl_b32 s59, s59, 18
    s_or_b32 s48, s58, s59
    s_lshl_b32 s58, s44, 13
    s_add_u32 s48, s48, s58
    s_mul_i32 s49, s3, 8320
    s_and_b32 s90, s2, 3
    s_lshl_b32 s90, s90, 7
    s_add_u32 s90, s90, 2
    v_lshl_add_u32 v240, v1, 1, s90
    s_and_b32 s91, s2, 0xfc
    s_add_u32 s91, s91, s3
    s_lshr_b32 s90, s91, 4
    s_lshl_b32 s90, s90, 7
    s_and_b32 s91, s91, 15
    s_add_u32 s90, s90, s91
    s_mul_i32 s90, s90, 514
    s_add_u32 s91, s90, 0
    buffer_load_ushort v216, v240, s[24:27], s91 offen nt
    buffer_load_ushort v224, v240, s[28:31], s91 offen nt
    s_add_u32 s91, s90, 16448
    buffer_load_ushort v217, v240, s[24:27], s91 offen nt
    buffer_load_ushort v225, v240, s[28:31], s91 offen nt
    s_add_u32 s91, s90, 32896
    buffer_load_ushort v218, v240, s[24:27], s91 offen nt
    buffer_load_ushort v226, v240, s[28:31], s91 offen nt
    s_add_u32 s91, s90, 49344
    buffer_load_ushort v219, v240, s[24:27], s91 offen nt
    buffer_load_ushort v227, v240, s[28:31], s91 offen nt
    s_add_u32 s91, s90, 8224
    buffer_load_ushort v220, v240, s[24:27], s91 offen nt
    buffer_load_ushort v228, v240, s[28:31], s91 offen nt
    s_add_u32 s91, s90, 24672
    buffer_load_ushort v221, v240, s[24:27], s91 offen nt
    buffer_load_ushort v229, v240, s[28:31], s91 offen nt
    s_add_u32 s91, s90, 41120
    buffer_load_ushort v222, v240, s[24:27], s91 offen nt
    buffer_load_ushort v230, v240, s[28:31], s91 offen nt
    s_add_u32 s91, s90, 57568
    buffer_load_ushort v223, v240, s[24:27], s91 offen nt
    buffer_load_ushort v231, v240, s[28:31], s91 offen nt
    s_lshl_b32 s72, s44, 2
    s_add_u32 s72, s72, s43
    s_lshl_b32 s58, s43, 11
    s_add_u32 s64, s48, s58
    s_add_u32 s65, s64, 1024
    s_mul_i32 s49, s3, 4224
    v_add_u32 v9, 64480, v8
    v_add_u32 v10, 128960, v8
    v_add_u32 v11, 193440, v8
    v_and_b32 v4, 31, v1
    v_and_b32 v6, 1, v1
    v_mul_u32_u24 v6, 0x8000, v6
    v_lshl_or_b32 v6, v6, 16, v6
    v_cvt_f32_u32 v4, v4
    v_mul_f32 v7, 0x3b000000, v4
    v_mul_f32 v4, 0x3c000000, v4
    v_lshrrev_b32 v5, 5, v1
    v_cvt_f32_u32 v5, v5
    v_mul_f32 v5, 0x41000000, v5
    v_mul_f32 v5, v5, v4
    s_mov_b32 s73, 0x07060100
    s_mov_b32 s74, 0x80008000
    s_mov_b32 s75, 0x80000000
    s_mov_b32 s76, 0x00008000
    v_fmamk_f32 v48, v4, 0x00000000, v5
    v_fmamk_f32 v49, v4, 0x3f800000, v5
    v_fmamk_f32 v50, v4, 0x40000000, v5
    v_fmamk_f32 v51, v4, 0x40400000, v5
    v_fmamk_f32 v52, v4, 0x40800000, v5
    v_fmamk_f32 v53, v4, 0x40a00000, v5
    v_fmamk_f32 v54, v4, 0x40c00000, v5
    v_fmamk_f32 v55, v4, 0x40e00000, v5
    v_cos_f32 v56, v48
    v_cos_f32 v57, v49
    v_cos_f32 v58, v50
    v_cos_f32 v59, v51
    v_cos_f32 v60, v52
    v_cos_f32 v61, v53
    v_cos_f32 v62, v54
    v_cos_f32 v63, v55
    v_sin_f32 v48, -v48
    v_sin_f32 v49, -v49
    v_sin_f32 v50, -v50
    v_sin_f32 v51, -v51
    v_sin_f32 v52, -v52
    v_sin_f32 v53, -v53
    v_sin_f32 v54, -v54
    v_sin_f32 v55, -v55
    v_cvt_pk_bf16_f32 v128, v56, v57
    v_cvt_pk_bf16_f32 v132, v48, v49
    v_cvt_pk_bf16_f32 v129, v58, v59
    v_cvt_pk_bf16_f32 v133, v50, v51
    v_cvt_pk_bf16_f32 v130, v60, v61
    v_cvt_pk_bf16_f32 v134, v52, v53
    v_cvt_pk_bf16_f32 v131, v62, v63
    v_cvt_pk_bf16_f32 v135, v54, v55
    v_xor_b32 v160, v6, v128
    v_xor_b32 v161, v6, v129
    v_xor_b32 v162, v6, v130
    v_xor_b32 v163, v6, v131
    v_xor_b32 v164, v6, v132
    v_xor_b32 v165, v6, v133
    v_xor_b32 v166, v6, v134
    v_xor_b32 v167, v6, v135
    v_fmamk_f32 v48, v4, 0x41800000, v5
    v_fmamk_f32 v49, v4, 0x41880000, v5
    v_fmamk_f32 v50, v4, 0x41900000, v5
    v_fmamk_f32 v51, v4, 0x41980000, v5
    v_fmamk_f32 v52, v4, 0x41a00000, v5
    v_fmamk_f32 v53, v4, 0x41a80000, v5
    v_fmamk_f32 v54, v4, 0x41b00000, v5
    v_fmamk_f32 v55, v4, 0x41b80000, v5
    v_cos_f32 v56, v48
    v_cos_f32 v57, v49
    v_cos_f32 v58, v50
    v_cos_f32 v59, v51
    v_cos_f32 v60, v52
    v_cos_f32 v61, v53
    v_cos_f32 v62, v54
    v_cos_f32 v63, v55
    v_sin_f32 v48, -v48
    v_sin_f32 v49, -v49
    v_sin_f32 v50, -v50
    v_sin_f32 v51, -v51
    v_sin_f32 v52, -v52
    v_sin_f32 v53, -v53
    v_sin_f32 v54, -v54
    v_sin_f32 v55, -v55
    v_cvt_pk_bf16_f32 v136, v56, v57
    v_cvt_pk_bf16_f32 v140, v48, v49
    v_cvt_pk_bf16_f32 v137, v58, v59
    v_cvt_pk_bf16_f32 v141, v50, v51
    v_cvt_pk_bf16_f32 v138, v60, v61
    v_cvt_pk_bf16_f32 v142, v52, v53
    v_cvt_pk_bf16_f32 v139, v62, v63
    v_cvt_pk_bf16_f32 v143, v54, v55
    v_xor_b32 v168, v6, v136
    v_xor_b32 v169, v6, v137
    v_xor_b32 v170, v6, v138
    v_xor_b32 v171, v6, v139
    v_xor_b32 v172, v6, v140
    v_xor_b32 v173, v6, v141
    v_xor_b32 v174, v6, v142
    v_xor_b32 v175, v6, v143
    v_fmamk_f32 v48, v4, 0x42000000, v5
    v_fmamk_f32 v49, v4, 0x42040000, v5
    v_fmamk_f32 v50, v4, 0x42080000, v5
    v_fmamk_f32 v51, v4, 0x420c0000, v5
    v_fmamk_f32 v52, v4, 0x42100000, v5
    v_fmamk_f32 v53, v4, 0x42140000, v5
    v_fmamk_f32 v54, v4, 0x42180000, v5
    v_fmamk_f32 v55, v4, 0x421c0000, v5
    v_cos_f32 v56, v48
    v_cos_f32 v57, v49
    v_cos_f32 v58, v50
    v_cos_f32 v59, v51
    v_cos_f32 v60, v52
    v_cos_f32 v61, v53
    v_cos_f32 v62, v54
    v_cos_f32 v63, v55
    v_sin_f32 v48, -v48
    v_sin_f32 v49, -v49
    v_sin_f32 v50, -v50
    v_sin_f32 v51, -v51
    v_sin_f32 v52, -v52
    v_sin_f32 v53, -v53
    v_sin_f32 v54, -v54
    v_sin_f32 v55, -v55
    v_cvt_pk_bf16_f32 v144, v56, v57
    v_cvt_pk_bf16_f32 v148, v48, v49
    v_cvt_pk_bf16_f32 v145, v58, v59
    v_cvt_pk_bf16_f32 v149, v50, v51
    v_cvt_pk_bf16_f32 v146, v60, v61
    v_cvt_pk_bf16_f32 v150, v52, v53
    v_cvt_pk_bf16_f32 v147, v62, v63
    v_cvt_pk_bf16_f32 v151, v54, v55
    v_xor_b32 v176, v6, v144
    v_xor_b32 v177, v6, v145
    v_xor_b32 v178, v6, v146
    v_xor_b32 v179, v6, v147
    v_xor_b32 v180, v6, v148
    v_xor_b32 v181, v6, v149
    v_xor_b32 v182, v6, v150
    v_xor_b32 v183, v6, v151
    v_fmamk_f32 v48, v4, 0x42400000, v5
    v_fmamk_f32 v49, v4, 0x42440000, v5
    v_fmamk_f32 v50, v4, 0x42480000, v5
    v_fmamk_f32 v51, v4, 0x424c0000, v5
    v_fmamk_f32 v52, v4, 0x42500000, v5
    v_fmamk_f32 v53, v4, 0x42540000, v5
    v_fmamk_f32 v54, v4, 0x42580000, v5
    v_fmamk_f32 v55, v4, 0x425c0000, v5
    v_cos_f32 v56, v48
    v_cos_f32 v57, v49
    v_cos_f32 v58, v50
    v_cos_f32 v59, v51
    v_cos_f32 v60, v52
    v_cos_f32 v61, v53
    v_cos_f32 v62, v54
    s_add_u32 m0, s49, 0
    s_nop 0
    buffer_load_dwordx4 v8, s[8:11], s64 offen offset:0 lds
    v_cos_f32 v63, v55
    v_sin_f32 v48, -v48
    v_sin_f32 v49, -v49
    v_sin_f32 v50, -v50
    v_sin_f32 v51, -v51
    v_sin_f32 v52, -v52
    v_sin_f32 v53, -v53
    v_sin_f32 v54, -v54
    buffer_load_dwordx4 v9, s[8:11], s64 offen offset:1056 lds
    v_sin_f32 v55, -v55
    v_cvt_pk_bf16_f32 v152, v56, v57
    v_cvt_pk_bf16_f32 v156, v48, v49
    v_cvt_pk_bf16_f32 v153, v58, v59
    v_cvt_pk_bf16_f32 v157, v50, v51
    v_cvt_pk_bf16_f32 v154, v60, v61
    v_cvt_pk_bf16_f32 v158, v52, v53
    v_cvt_pk_bf16_f32 v155, v62, v63
    v_cvt_pk_bf16_f32 v159, v54, v55
    v_xor_b32 v184, v6, v152
    v_xor_b32 v185, v6, v153
    v_xor_b32 v186, v6, v154
    v_xor_b32 v187, v6, v155
    v_xor_b32 v188, v6, v156
    buffer_load_dwordx4 v10, s[8:11], s64 offen offset:2112 lds
    v_xor_b32 v189, v6, v157
    v_xor_b32 v190, v6, v158
    v_xor_b32 v191, v6, v159
    v_perm_b32 v64, v132, v128, s73
    v_perm_b32 v65, v128, v132, s73
    v_xor_b32 v65, s75, v65
    v_accvgpr_write_b32 a64, v64
    v_accvgpr_write_b32 a68, v65
    v_perm_b32 v66, v133, v129, s73
    v_perm_b32 v67, v129, v133, s73
    v_xor_b32 v66, s74, v66
    v_xor_b32 v67, s76, v67
    v_accvgpr_write_b32 a65, v66
    v_accvgpr_write_b32 a69, v67
    v_perm_b32 v64, v134, v130, s73
    buffer_load_dwordx4 v11, s[8:11], s64 offen offset:3168 lds
    v_perm_b32 v65, v130, v134, s73
    v_xor_b32 v65, s75, v65
    v_accvgpr_write_b32 a66, v64
    v_accvgpr_write_b32 a70, v65
    v_perm_b32 v66, v135, v131, s73
    v_perm_b32 v67, v131, v135, s73
    v_xor_b32 v66, s74, v66
    v_xor_b32 v67, s76, v67
    v_accvgpr_write_b32 a67, v66
    v_accvgpr_write_b32 a71, v67
    v_perm_b32 v68, v140, v136, s73
    v_perm_b32 v69, v136, v140, s73
    v_xor_b32 v69, s75, v69
    v_accvgpr_write_b32 a72, v68
    v_accvgpr_write_b32 a76, v69
    s_add_u32 m0, s49, 16896
    s_add_u32 s64, s64, 524288
    buffer_load_dwordx4 v8, s[8:11], s64 offen offset:0 lds
    v_perm_b32 v70, v141, v137, s73
    v_perm_b32 v71, v137, v141, s73
    v_xor_b32 v70, s74, v70
    v_xor_b32 v71, s76, v71
    v_accvgpr_write_b32 a73, v70
    v_accvgpr_write_b32 a77, v71
    v_perm_b32 v68, v142, v138, s73
    v_perm_b32 v69, v138, v142, s73
    v_xor_b32 v69, s75, v69
    v_accvgpr_write_b32 a74, v68
    v_accvgpr_write_b32 a78, v69
    v_perm_b32 v70, v143, v139, s73
    v_perm_b32 v71, v139, v143, s73
    v_xor_b32 v70, s74, v70
    v_xor_b32 v71, s76, v71
    v_accvgpr_write_b32 a75, v70
    buffer_load_dwordx4 v9, s[8:11], s64 offen offset:1056 lds
    v_accvgpr_write_b32 a79, v71
    v_perm_b32 v64, v148, v144, s73
    v_perm_b32 v65, v144, v148, s73
    v_xor_b32 v65, s75, v65
    v_accvgpr_write_b32 a80, v64
    v_accvgpr_write_b32 a84, v65
    v_perm_b32 v66, v149, v145, s73
    v_perm_b32 v67, v145, v149, s73
    v_xor_b32 v66, s74, v66
    v_xor_b32 v67, s76, v67
    v_accvgpr_write_b32 a81, v66
    v_accvgpr_write_b32 a85, v67
    v_perm_b32 v64, v150, v146, s73
    v_perm_b32 v65, v146, v150, s73
    v_xor_b32 v65, s75, v65
    buffer_load_dwordx4 v10, s[8:11], s64 offen offset:2112 lds
    v_accvgpr_write_b32 a82, v64
    v_accvgpr_write_b32 a86, v65
    v_perm_b32 v66, v151, v147, s73
    v_perm_b32 v67, v147, v151, s73
    v_xor_b32 v66, s74, v66
    v_xor_b32 v67, s76, v67
    v_accvgpr_write_b32 a83, v66
    v_accvgpr_write_b32 a87, v67
    v_perm_b32 v68, v156, v152, s73
    v_perm_b32 v69, v152, v156, s73
    v_xor_b32 v69, s75, v69
    v_accvgpr_write_b32 a88, v68
    v_accvgpr_write_b32 a92, v69
    v_perm_b32 v70, v157, v153, s73
    v_perm_b32 v71, v153, v157, s73
    buffer_load_dwordx4 v11, s[8:11], s64 offen offset:3168 lds
    v_xor_b32 v70, s74, v70
    v_xor_b32 v71, s76, v71
    v_accvgpr_write_b32 a89, v70
    v_accvgpr_write_b32 a93, v71
    v_perm_b32 v68, v158, v154, s73
    v_perm_b32 v69, v154, v158, s73
    v_xor_b32 v69, s75, v69
    v_accvgpr_write_b32 a90, v68
    v_accvgpr_write_b32 a94, v69
    v_perm_b32 v70, v159, v155, s73
    v_perm_b32 v71, v155, v159, s73
    v_xor_b32 v70, s74, v70
    v_xor_b32 v71, s76, v71
    v_accvgpr_write_b32 a91, v70
    v_accvgpr_write_b32 a95, v71
    s_add_u32 m0, s49, 33792
    s_nop 0
    buffer_load_dwordx4 v8, s[8:11], s65 offen offset:0 lds
    v_perm_b32 v64, v164, v160, s73
    v_perm_b32 v65, v160, v164, s73
    v_xor_b32 v65, s75, v65
    v_accvgpr_write_b32 a96, v64
    v_accvgpr_write_b32 a100, v65
    v_perm_b32 v66, v165, v161, s73
    v_perm_b32 v67, v161, v165, s73
    v_xor_b32 v66, s74, v66
    v_xor_b32 v67, s76, v67
    v_accvgpr_write_b32 a97, v66
    v_accvgpr_write_b32 a101, v67
    v_perm_b32 v64, v166, v162, s73
    v_perm_b32 v65, v162, v166, s73
    v_xor_b32 v65, s75, v65
    v_accvgpr_write_b32 a98, v64
    v_accvgpr_write_b32 a102, v65
    buffer_load_dwordx4 v9, s[8:11], s65 offen offset:1056 lds
    v_perm_b32 v66, v167, v163, s73
    v_perm_b32 v67, v163, v167, s73
    v_xor_b32 v66, s74, v66
    v_xor_b32 v67, s76, v67
    v_accvgpr_write_b32 a99, v66
    v_accvgpr_write_b32 a103, v67
    v_perm_b32 v68, v172, v168, s73
    v_perm_b32 v69, v168, v172, s73
    v_xor_b32 v69, s75, v69
    v_accvgpr_write_b32 a104, v68
    v_accvgpr_write_b32 a108, v69
    v_perm_b32 v70, v173, v169, s73
    v_perm_b32 v71, v169, v173, s73
    v_xor_b32 v70, s74, v70
    v_xor_b32 v71, s76, v71
    buffer_load_dwordx4 v10, s[8:11], s65 offen offset:2112 lds
    v_accvgpr_write_b32 a105, v70
    v_accvgpr_write_b32 a109, v71
    v_perm_b32 v68, v174, v170, s73
    v_perm_b32 v69, v170, v174, s73
    v_xor_b32 v69, s75, v69
    v_accvgpr_write_b32 a106, v68
    v_accvgpr_write_b32 a110, v69
    v_perm_b32 v70, v175, v171, s73
    v_perm_b32 v71, v171, v175, s73
    v_xor_b32 v70, s74, v70
    v_xor_b32 v71, s76, v71
    v_accvgpr_write_b32 a107, v70
    v_accvgpr_write_b32 a111, v71
    v_perm_b32 v64, v180, v176, s73
    v_perm_b32 v65, v176, v180, s73
    buffer_load_dwordx4 v11, s[8:11], s65 offen offset:3168 lds
    v_xor_b32 v65, s75, v65
    v_accvgpr_write_b32 a112, v64
    v_accvgpr_write_b32 a116, v65
    v_perm_b32 v66, v181, v177, s73
    v_perm_b32 v67, v177, v181, s73
    v_xor_b32 v66, s74, v66
    v_xor_b32 v67, s76, v67
    v_accvgpr_write_b32 a113, v66
    v_accvgpr_write_b32 a117, v67
    v_perm_b32 v64, v182, v178, s73
    v_perm_b32 v65, v178, v182, s73
    v_xor_b32 v65, s75, v65
    v_accvgpr_write_b32 a114, v64
    v_accvgpr_write_b32 a118, v65
    v_perm_b32 v66, v183, v179, s73
    v_perm_b32 v67, v179, v183, s73
    s_add_u32 m0, s49, 50688
    s_add_u32 s65, s65, 524288
    buffer_load_dwordx4 v8, s[8:11], s65 offen offset:0 lds
    v_xor_b32 v66, s74, v66
    v_xor_b32 v67, s76, v67
    v_accvgpr_write_b32 a115, v66
    v_accvgpr_write_b32 a119, v67
    v_perm_b32 v68, v188, v184, s73
    v_perm_b32 v69, v184, v188, s73
    v_xor_b32 v69, s75, v69
    v_accvgpr_write_b32 a120, v68
    v_accvgpr_write_b32 a124, v69
    v_perm_b32 v70, v189, v185, s73
    v_perm_b32 v71, v185, v189, s73
    v_xor_b32 v70, s74, v70
    v_xor_b32 v71, s76, v71
    v_accvgpr_write_b32 a121, v70
    v_accvgpr_write_b32 a125, v71
    buffer_load_dwordx4 v9, s[8:11], s65 offen offset:1056 lds
    v_perm_b32 v68, v190, v186, s73
    v_perm_b32 v69, v186, v190, s73
    v_xor_b32 v69, s75, v69
    v_accvgpr_write_b32 a122, v68
    v_accvgpr_write_b32 a126, v69
    v_perm_b32 v70, v191, v187, s73
    v_perm_b32 v71, v187, v191, s73
    v_xor_b32 v70, s74, v70
    v_xor_b32 v71, s76, v71
    v_accvgpr_write_b32 a123, v70
    v_accvgpr_write_b32 a127, v71
    v_mul_f32 v48, 0x00000000, v7
    v_mul_f32 v49, 0x3f800000, v7
    v_mul_f32 v50, 0x40000000, v7
    v_mul_f32 v51, 0x40400000, v7
    buffer_load_dwordx4 v10, s[8:11], s65 offen offset:2112 lds
    v_cos_f32 v192, v48
    v_sin_f32 v196, v48
    v_cos_f32 v193, v49
    v_sin_f32 v197, v49
    v_cos_f32 v194, v50
    v_sin_f32 v198, v50
    v_cos_f32 v195, v51
    v_sin_f32 v199, v51
    buffer_load_dwordx4 v11, s[8:11], s65 offen offset:3168 lds
    v_mul_f32 v48, 0x00000000, v7
    v_add_f32 v48, 0x00000000, v48
    v_mul_f32 v49, 0x3f800000, v7
    v_add_f32 v49, 0x3d800000, v49
    v_mul_f32 v50, 0x40000000, v7
    v_add_f32 v50, 0x3e000000, v50
    v_mul_f32 v51, 0x40400000, v7
    v_add_f32 v51, 0x3e400000, v51
    v_cos_f32 v200, v48
    v_sin_f32 v204, v48
    v_cos_f32 v201, v49
    v_sin_f32 v205, v49
    v_cos_f32 v202, v50
    v_sin_f32 v206, v50
    v_cos_f32 v203, v51
    v_sin_f32 v207, v51
    v_and_b32 v3, 1, v1
    v_lshlrev_b32 v3, 2, v3
    v_bfe_u32 v13, v1, 4, 1
    v_lshl_or_b32 v3, v13, 1, v3
    v_bfe_u32 v13, v1, 1, 1
    v_or_b32 v3, v3, v13
    v_mul_u32_u24 v3, 1056, v3
    v_bfe_u32 v13, v1, 2, 2
    v_lshl_add_u32 v3, v13, 3, v3
    v_lshrrev_b32 v13, 5, v1
    v_lshl_add_u32 v3, v13, 6, v3
    s_mul_i32 s56, s3, 16896
    v_add_u32 v3, s56, v3
    v_and_b32 v4, 31, v1
    v_mul_u32_u24 v4, 144, v4
    v_lshl_add_u32 v4, v13, 3, v4
    s_lshl_b32 s56, s3, 5
    s_add_u32 s56, s56, 67584
    v_add_u32 v4, s56, v4
    v_lshlrev_b32 v6, 4, v13
    s_lshl_b32 s56, s3, 6
    s_add_u32 s56, s56, 141312
    v_add_u32 v6, s56, v6
    v_lshrrev_b32 v13, 3, v1
    v_and_b32 v14, 7, v1
    v_lshlrev_b32 v14, 4, v14
    v_mul_u32_u24 v5, 144, v13
    s_mul_i32 s56, s3, 9216
    s_add_u32 s56, s56, 67584
    v_add3_u32 v5, v5, v14, s56
    s_and_b32 s56, s3, 1
    s_sub_u32 s56, 0, s56
    v_xor_b32 v7, s56, v13
    v_and_b32 v7, 7, v7
    v_lshl_add_u32 v7, v7, 13, v14
    s_mov_b32 exec_lo, 1
    s_mov_b32 exec_hi, 1
    v_mov_b32 v132, 0xbf803f80
    v_mov_b32 v133, 0xbf803f80
    v_mov_b32 v134, 0xbf803f80
    v_mov_b32 v135, 0xbf803f80
    v_mov_b32 v140, 0xbf803f80
    v_mov_b32 v141, 0xbf803f80
    v_mov_b32 v142, 0xbf803f80
    v_mov_b32 v143, 0xbf803f80
    v_mov_b32 v148, 0xbf803f80
    v_mov_b32 v149, 0xbf803f80
    v_mov_b32 v150, 0xbf803f80
    v_mov_b32 v151, 0xbf803f80
    v_mov_b32 v156, 0xbf803f80
    v_mov_b32 v157, 0xbf803f80
    v_mov_b32 v158, 0xbf803f80
    v_mov_b32 v159, 0xbf803f80
    v_mov_b32 v164, 0xbf803f80
    v_mov_b32 v165, 0xbf803f80
    v_mov_b32 v166, 0xbf803f80
    v_mov_b32 v167, 0xbf803f80
    v_mov_b32 v172, 0xbf803f80
    v_mov_b32 v173, 0xbf803f80
    v_mov_b32 v174, 0xbf803f80
    v_mov_b32 v175, 0xbf803f80
    v_mov_b32 v180, 0xbf803f80
    v_mov_b32 v181, 0xbf803f80
    v_mov_b32 v182, 0xbf803f80
    v_mov_b32 v183, 0xbf803f80
    v_mov_b32 v188, 0xbf803f80
    v_mov_b32 v189, 0xbf803f80
    v_mov_b32 v190, 0xbf803f80
    v_mov_b32 v191, 0xbf803f80
    s_mov_b64 exec, -1
    s_waitcnt vmcnt(33)
    v_lshlrev_b32 v24, 16, v16
    v_and_b32 v25, 0xffff0000, v16
    v_lshlrev_b32 v26, 16, v17
    v_and_b32 v27, 0xffff0000, v17
    v_lshlrev_b32 v28, 16, v18
    v_and_b32 v29, 0xffff0000, v18
    v_lshlrev_b32 v30, 16, v19
    v_and_b32 v31, 0xffff0000, v19
    s_waitcnt vmcnt(32)
    v_lshlrev_b32 v32, 16, v20
    v_and_b32 v33, 0xffff0000, v20
    v_lshlrev_b32 v34, 16, v21
    v_and_b32 v35, 0xffff0000, v21
    v_lshlrev_b32 v36, 16, v22
    v_and_b32 v37, 0xffff0000, v22
    v_lshlrev_b32 v38, 16, v23
    v_and_b32 v39, 0xffff0000, v23
    v_add_f32 v16, v24, v25
    v_add_f32 v17, v32, v33
    v_add_f32 v16, v16, v26
    v_add_f32 v17, v17, v34
    v_add_f32 v16, v16, v27
    v_add_f32 v17, v17, v35
    v_add_f32 v16, v16, v28
    v_add_f32 v17, v17, v36
    v_add_f32 v16, v16, v29
    v_add_f32 v17, v17, v37
    v_add_f32 v16, v16, v30
    v_add_f32 v17, v17, v38
    v_add_f32 v16, v16, v31
    v_add_f32 v17, v17, v39
    s_nop 0
    v_add_f32_dpp v16, v16, v16 row_shr:1 row_mask:0xf bank_mask:0xf bound_ctrl:0
    v_add_f32_dpp v17, v17, v17 row_shr:1 row_mask:0xf bank_mask:0xf bound_ctrl:0
    s_nop 0
    v_add_f32_dpp v16, v16, v16 row_shr:2 row_mask:0xf bank_mask:0xf bound_ctrl:0
    v_add_f32_dpp v17, v17, v17 row_shr:2 row_mask:0xf bank_mask:0xf bound_ctrl:0
    s_nop 0
    v_add_f32_dpp v16, v16, v16 row_shr:4 row_mask:0xf bank_mask:0xf bound_ctrl:0
    v_add_f32_dpp v17, v17, v17 row_shr:4 row_mask:0xf bank_mask:0xf bound_ctrl:0
    s_nop 0
    v_add_f32_dpp v16, v16, v16 row_shr:8 row_mask:0xf bank_mask:0xf bound_ctrl:0
    v_add_f32_dpp v17, v17, v17 row_shr:8 row_mask:0xf bank_mask:0xf bound_ctrl:0
    s_nop 0
    v_add_f32_dpp v16, v16, v16 row_bcast:15 row_mask:0xa bank_mask:0xf
    v_add_f32_dpp v17, v17, v17 row_bcast:15 row_mask:0xa bank_mask:0xf
    s_nop 0
    v_add_f32_dpp v16, v16, v16 row_bcast:31 row_mask:0xc bank_mask:0xf
    v_add_f32_dpp v17, v17, v17 row_bcast:31 row_mask:0xc bank_mask:0xf
    v_readlane_b32 s56, v16, 63
    v_readlane_b32 s57, v17, 63
    s_nop 0
    v_mov_b32 v18, s56
    v_mul_f32 v18, 0xbb000000, v18
    v_mov_b32 v19, s57
    v_mul_f32 v19, 0xbb000000, v19
    v_add_f32 v24, v24, v18
    v_add_f32 v32, v32, v19
    v_add_f32 v25, v25, v18
    v_add_f32 v33, v33, v19
    v_add_f32 v26, v26, v18
    v_add_f32 v34, v34, v19
    v_add_f32 v27, v27, v18
    v_add_f32 v35, v35, v19
    v_add_f32 v28, v28, v18
    v_add_f32 v36, v36, v19
    v_add_f32 v29, v29, v18
    v_add_f32 v37, v37, v19
    v_add_f32 v30, v30, v18
    v_add_f32 v38, v38, v19
    v_add_f32 v31, v31, v18
    v_add_f32 v39, v39, v19
    v_mul_f32 v16, v24, v24
    v_mul_f32 v17, v32, v32
    v_fmac_f32 v16, v25, v25
    v_fmac_f32 v17, v33, v33
    v_fmac_f32 v16, v26, v26
    v_fmac_f32 v17, v34, v34
    v_fmac_f32 v16, v27, v27
    v_fmac_f32 v17, v35, v35
    v_fmac_f32 v16, v28, v28
    v_fmac_f32 v17, v36, v36
    v_fmac_f32 v16, v29, v29
    v_fmac_f32 v17, v37, v37
    v_fmac_f32 v16, v30, v30
    v_fmac_f32 v17, v38, v38
    v_fmac_f32 v16, v31, v31
    v_fmac_f32 v17, v39, v39
    s_nop 0
    v_add_f32_dpp v16, v16, v16 row_shr:1 row_mask:0xf bank_mask:0xf bound_ctrl:0
    v_add_f32_dpp v17, v17, v17 row_shr:1 row_mask:0xf bank_mask:0xf bound_ctrl:0
    s_nop 0
    v_add_f32_dpp v16, v16, v16 row_shr:2 row_mask:0xf bank_mask:0xf bound_ctrl:0
    v_add_f32_dpp v17, v17, v17 row_shr:2 row_mask:0xf bank_mask:0xf bound_ctrl:0
    s_nop 0
    v_add_f32_dpp v16, v16, v16 row_shr:4 row_mask:0xf bank_mask:0xf bound_ctrl:0
    v_add_f32_dpp v17, v17, v17 row_shr:4 row_mask:0xf bank_mask:0xf bound_ctrl:0
    s_nop 0
    v_add_f32_dpp v16, v16, v16 row_shr:8 row_mask:0xf bank_mask:0xf bound_ctrl:0
    v_add_f32_dpp v17, v17, v17 row_shr:8 row_mask:0xf bank_mask:0xf bound_ctrl:0
    s_nop 0
    v_add_f32_dpp v16, v16, v16 row_bcast:15 row_mask:0xa bank_mask:0xf
    v_add_f32_dpp v17, v17, v17 row_bcast:15 row_mask:0xa bank_mask:0xf
    s_nop 0
    v_add_f32_dpp v16, v16, v16 row_bcast:31 row_mask:0xc bank_mask:0xf
    v_add_f32_dpp v17, v17, v17 row_bcast:31 row_mask:0xc bank_mask:0xf
    v_readlane_b32 s56, v16, 63
    v_readlane_b32 s57, v17, 63
    s_nop 0
    v_mov_b32 v21, s56
    v_mov_b32 v22, s57
    v_cmp_eq_u32 vcc, 0, v1
    s_nop 1
    v_cndmask_b32 v20, v19, v18, vcc
    v_cndmask_b32 v21, v22, v21, vcc
    v_mov_b32 v23, 0x3727c5ac
    v_fmamk_f32 v21, v21, 0x3b000000, v23
    v_rsq_f32 v22, v21
    v_cvt_pk_bf16_f32 v24, v20, v20
    v_and_b32 v24, 0xffff0000, v24
    v_sub_f32 v25, v20, v24
    v_cvt_pk_bf16_f32 v20, v24, v25
    s_waitcnt lgkmcnt(0)
    s_mul_i32 s40, s40, 0x9E3779B1
    s_add_u32 s40, s40, 0x7F4A7C15
    v_mul_f32 v22, 0xc0135761, v22
    v_mov_b32 v23, s40
    s_lshl_b32 s56, s1, 7
    s_lshl_b32 s57, s3, 5
    s_add_u32 s56, s56, s57
    s_add_u32 s56, s56, 65536
    s_mov_b64 exec, 3
    buffer_store_dwordx4 v[20:23], v2, s[36:39], s56 offen sc1
    s_mov_b64 exec, -1
    s_lshl_b32 s56, s3, 3
    s_lshr_b32 s56, 0x787ff8ff, s56
    s_and_b32 s56, s56, 0xff
    s_cmp_eq_u32 s3, 0
    s_cselect_b32 s56, -1, s56
    s_lshl_b32 s77, s56, 13
    s_lshl_b32 s57, s72, 7
    s_add_u32 s77, s77, s57
    s_add_u32 s77, s77, 1048576
    s_and_b32 s56, s3, 1
    s_cmp_eq_u32 s56, 0
    s_mov_b32 s78, 65536
    s_cselect_b32 s78, s78, 4294901760
    s_cmp_eq_u32 s3, 0
    s_cselect_b32 s56, 524288, 0
    s_cmp_eq_u32 s3, 3
    s_cselect_b32 s56, 524288, s56
    v_cmp_gt_u32 vcc, 8, v1
    v_mov_b32 v12, s56
    s_nop 0
    v_cndmask_b32 v12, 0, v12, vcc
    v_add_u32 v12, v12, v7
    s_lshl_b32 s56, s72, 10
    s_add_u32 s79, s56, 65536
    v_bfe_u32 v13, v1, 2, 1
    v_lshlrev_b32 v13, 4, v13
    v_bfe_u32 v14, v1, 3, 2
    v_lshl_or_b32 v13, v14, 2, v13
    v_and_b32 v14, 35, v1
    v_or_b32 v13, v13, v14
    v_lshlrev_b32 v13, 2, v13
    v_add_u32 v13, 141312, v13
    s_waitcnt vmcnt(1)
    s_barrier
    ds_read_b64_tr_b16 a[0:1], v3 offset:0
    ds_read_b64_tr_b16 a[2:3], v3 offset:32
    ds_read_b64_tr_b16 a[4:5], v3 offset:128
    ds_read_b64_tr_b16 a[6:7], v3 offset:160
    ds_read_b64_tr_b16 a[8:9], v3 offset:256
    ds_read_b64_tr_b16 a[10:11], v3 offset:288
    ds_read_b64_tr_b16 a[12:13], v3 offset:384
    ds_read_b64_tr_b16 a[14:15], v3 offset:416
    ds_read_b64_tr_b16 a[16:17], v3 offset:512
    ds_read_b64_tr_b16 a[18:19], v3 offset:544
    ds_read_b64_tr_b16 a[20:21], v3 offset:640
    ds_read_b64_tr_b16 a[22:23], v3 offset:672
    ds_read_b64_tr_b16 a[24:25], v3 offset:768
    ds_read_b64_tr_b16 a[26:27], v3 offset:800
    ds_read_b64_tr_b16 a[28:29], v3 offset:896
    ds_read_b64_tr_b16 a[30:31], v3 offset:928
    ds_read_b64_tr_b16 a[32:33], v3 offset:8448
    ds_read_b64_tr_b16 a[34:35], v3 offset:8480
    ds_read_b64_tr_b16 a[36:37], v3 offset:8576
    ds_read_b64_tr_b16 a[38:39], v3 offset:8608
    ds_read_b64_tr_b16 a[40:41], v3 offset:8704
    ds_read_b64_tr_b16 a[42:43], v3 offset:8736
    ds_read_b64_tr_b16 a[44:45], v3 offset:8832
    ds_read_b64_tr_b16 a[46:47], v3 offset:8864
    ds_read_b64_tr_b16 a[48:49], v3 offset:8960
    ds_read_b64_tr_b16 a[50:51], v3 offset:8992
    ds_read_b64_tr_b16 a[52:53], v3 offset:9088
    ds_read_b64_tr_b16 a[54:55], v3 offset:9120
    ds_read_b64_tr_b16 a[56:57], v3 offset:9216
    ds_read_b64_tr_b16 a[58:59], v3 offset:9248
    ds_read_b64_tr_b16 a[60:61], v3 offset:9344
    ds_read_b64_tr_b16 a[62:63], v3 offset:9376
    buffer_load_dwordx4 v[80:83], v2, s[36:39], s79 offen sc1
    s_mov_b32 s0, 0x3f3504f3
    s_waitcnt lgkmcnt(15)
    v_mfma_f32_32x32x16_bf16 v[16:31], a[0:3], v[128:131], 0
    v_mfma_f32_32x32x16_bf16 v[32:47], a[0:3], v[132:135], 0
    v_mfma_f32_32x32x16_bf16 v[16:31], a[4:7], v[136:139], v[16:31]
    v_mfma_f32_32x32x16_bf16 v[32:47], a[4:7], v[140:143], v[32:47]
    v_mfma_f32_32x32x16_bf16 v[16:31], a[8:11], v[144:147], v[16:31]
    v_mfma_f32_32x32x16_bf16 v[32:47], a[8:11], v[148:151], v[32:47]
    v_mfma_f32_32x32x16_bf16 v[16:31], a[12:15], v[152:155], v[16:31]
    v_mfma_f32_32x32x16_bf16 v[32:47], a[12:15], v[156:159], v[32:47]
    v_mfma_f32_32x32x16_bf16 v[16:31], a[16:19], v[160:163], v[16:31]
    v_mfma_f32_32x32x16_bf16 v[32:47], a[16:19], v[164:167], v[32:47]
    v_mfma_f32_32x32x16_bf16 v[16:31], a[20:23], v[168:171], v[16:31]
    v_mfma_f32_32x32x16_bf16 v[32:47], a[20:23], v[172:175], v[32:47]
    v_mfma_f32_32x32x16_bf16 v[16:31], a[24:27], v[176:179], v[16:31]
    v_mfma_f32_32x32x16_bf16 v[32:47], a[24:27], v[180:183], v[32:47]
    v_mfma_f32_32x32x16_bf16 v[16:31], a[28:31], v[184:187], v[16:31]
    v_mfma_f32_32x32x16_bf16 v[32:47], a[28:31], v[188:191], v[32:47]
    s_waitcnt lgkmcnt(14)
    v_mfma_f32_32x32x16_bf16 v[48:63], a[32:35], v[128:131], 0
    v_mfma_f32_32x32x16_bf16 v[64:79], a[32:35], v[132:135], 0
    s_waitcnt lgkmcnt(12)
    v_mfma_f32_32x32x16_bf16 v[48:63], a[36:39], v[136:139], v[48:63]
    v_mfma_f32_32x32x16_bf16 v[64:79], a[36:39], v[140:143], v[64:79]
    s_waitcnt lgkmcnt(10)
    v_mfma_f32_32x32x16_bf16 v[48:63], a[40:43], v[144:147], v[48:63]
    v_mfma_f32_32x32x16_bf16 v[64:79], a[40:43], v[148:151], v[64:79]
    s_waitcnt lgkmcnt(8)
    v_mfma_f32_32x32x16_bf16 v[48:63], a[44:47], v[152:155], v[48:63]
    v_mfma_f32_32x32x16_bf16 v[64:79], a[44:47], v[156:159], v[64:79]
    s_waitcnt lgkmcnt(6)
    v_mfma_f32_32x32x16_bf16 v[48:63], a[48:51], v[160:163], v[48:63]
    v_mfma_f32_32x32x16_bf16 v[64:79], a[48:51], v[164:167], v[64:79]
    s_waitcnt lgkmcnt(4)
    v_mfma_f32_32x32x16_bf16 v[48:63], a[52:55], v[168:171], v[48:63]
    v_mfma_f32_32x32x16_bf16 v[64:79], a[52:55], v[172:175], v[64:79]
    s_waitcnt lgkmcnt(2)
    v_mfma_f32_32x32x16_bf16 v[48:63], a[56:59], v[176:179], v[48:63]
    v_mfma_f32_32x32x16_bf16 v[64:79], a[56:59], v[180:183], v[64:79]
    s_waitcnt lgkmcnt(0)
    v_mfma_f32_32x32x16_bf16 v[48:63], a[60:63], v[184:187], v[48:63]
    v_mfma_f32_32x32x16_bf16 v[64:79], a[60:63], v[188:191], v[64:79]
    v_mfma_f32_32x32x16_bf16 v[128:143], a[0:3], a[64:67], 0
    v_mfma_f32_32x32x16_bf16 v[144:159], a[0:3], a[68:71], 0
    v_mfma_f32_32x32x16_bf16 v[128:143], a[4:7], a[72:75], v[128:143]
    s_lshr_b32 s58, s42, 3
    s_and_b32 s52, s42, 7
    s_mov_b32 s53, 0x1098badc
    s_mov_b32 s85, 0x765432
    s_cmp_eq_u32 s58, 1
    s_cselect_b32 s53, 0x3276dc54, s53
    s_cselect_b32 s85, 0x9810ba, s85
    s_cmp_eq_u32 s58, 2
    s_cselect_b32 s53, 0xdc769810, s53
    s_cselect_b32 s85, 0xba3254, s85
    s_cmp_eq_u32 s58, 3
    s_cselect_b32 s53, 0x7610ba32, s53
    s_cselect_b32 s85, 0xdc5498, s85
    s_and_b32 s58, s52, 3
    s_lshl_b32 s58, s58, 2
    s_and_b32 s59, s53, 0xffff
    s_mul_i32 s59, s59, 0x10001
    s_lshr_b32 s59, s59, s58
    s_and_b32 s56, s59, 0xffff
    s_lshr_b32 s59, s85, 8
    s_mul_i32 s59, s59, 0x10001
    s_lshr_b32 s59, s59, s58
    s_and_b32 s57, s59, 0xffff
    s_lshr_b32 s60, s53, 16
    s_and_b32 s59, s85, 0xff
    s_lshl_b32 s59, s59, 16
    s_or_b32 s60, s60, s59
    s_lshr_b32 s61, s60, 8
    s_lshl_b32 s59, s60, 24
    s_or_b32 s60, s60, s59
    s_mul_i32 s58, s52, 3
    s_and_b32 s58, s58, 28
    s_lshr_b64 s[60:61], s[60:61], s58
    s_lshl_b32 s53, s60, 16
    s_or_b32 s53, s53, s56
    s_bfe_u32 s85, s60, 524304
    s_lshl_b32 s57, s57, 8
    s_or_b32 s85, s85, s57
    v_mfma_f32_32x32x16_bf16 v[144:159], a[4:7], a[76:79], v[144:159]
    v_mfma_f32_32x32x16_bf16 v[128:143], a[8:11], a[80:83], v[128:143]
    v_lshl_or_b32 v216, v217, 16, v216
    v_mfma_f32_32x32x16_bf16 v[144:159], a[8:11], a[84:87], v[144:159]
    v_lshl_or_b32 v217, v219, 16, v218
    v_mfma_f32_32x32x16_bf16 v[128:143], a[12:15], a[88:91], v[128:143]
    v_mfma_f32_32x32x16_bf16 v[144:159], a[12:15], a[92:95], v[144:159]
    v_lshl_or_b32 v218, v221, 16, v220
    v_mfma_f32_32x32x16_bf16 v[128:143], a[16:19], a[96:99], v[128:143]
    v_lshl_or_b32 v219, v223, 16, v222
    v_mfma_f32_32x32x16_bf16 v[144:159], a[16:19], a[100:103], v[144:159]
    v_lshl_or_b32 v220, v225, 16, v224
    v_mfma_f32_32x32x16_bf16 v[128:143], a[20:23], a[104:107], v[128:143]
    v_lshl_or_b32 v221, v227, 16, v226
    v_mfma_f32_32x32x16_bf16 v[144:159], a[20:23], a[108:111], v[144:159]
    v_mfma_f32_32x32x16_bf16 v[128:143], a[24:27], a[112:115], v[128:143]
    v_lshl_or_b32 v222, v229, 16, v228
    v_mfma_f32_32x32x16_bf16 v[144:159], a[24:27], a[116:119], v[144:159]
    v_lshl_or_b32 v223, v231, 16, v230
    v_mfma_f32_32x32x16_bf16 v[128:143], a[28:31], a[120:123], v[128:143]
    s_lshl_b32 s90, s3, 5
    s_add_u32 s90, s90, 141824
    v_mfma_f32_32x32x16_bf16 v[144:159], a[28:31], a[124:127], v[144:159]
    v_mov_b32 v224, 144
    v_mfma_f32_32x32x16_bf16 v[160:175], a[32:35], a[64:67], 0
    v_mfma_f32_32x32x16_bf16 v[176:191], a[32:35], a[68:71], 0
    v_mad_u32_u24 v240, v1, v224, s90
    v_mfma_f32_32x32x16_bf16 v[160:175], a[36:39], a[72:75], v[160:175]
    ds_write_b128 v240, v[216:219]
    v_mfma_f32_32x32x16_bf16 v[176:191], a[36:39], a[76:79], v[176:191]
    v_mfma_f32_32x32x16_bf16 v[160:175], a[40:43], a[80:83], v[160:175]
    ds_write_b128 v240, v[220:223] offset:16
    v_mfma_f32_32x32x16_bf16 v[176:191], a[40:43], a[84:87], v[176:191]
    v_mfma_f32_32x32x16_bf16 v[160:175], a[44:47], a[88:91], v[160:175]
    v_mfma_f32_32x32x16_bf16 v[176:191], a[44:47], a[92:95], v[176:191]
    v_mfma_f32_32x32x16_bf16 v[160:175], a[48:51], a[96:99], v[160:175]
    s_waitcnt vmcnt(0)
    v_cmp_ne_u32 vcc, s40, v83
    s_nop 0
    s_cmp_lg_u64 vcc, 0
    s_cbranch_scc1 L_slow3
L_back3:
    v_mul_f32 v82, 0xbede652a, v82
    ds_write_b32 v13, v82
    ds_read_b128 v[208:211], v6 offset:0
    ds_read_b128 v[212:215], v6 offset:32
    v_mfma_f32_32x32x16_bf16 v[176:191], a[48:51], a[100:103], v[176:191]
    v_mfma_f32_32x32x16_bf16 v[160:175], a[52:55], a[104:107], v[160:175]
    v_mfma_f32_32x32x16_bf16 v[176:191], a[52:55], a[108:111], v[176:191]
    v_mfma_f32_32x32x16_bf16 v[160:175], a[56:59], a[112:115], v[160:175]
    v_mfma_f32_32x32x16_bf16 v[176:191], a[56:59], a[116:119], v[176:191]
    v_mfma_f32_32x32x16_bf16 v[160:175], a[60:63], a[120:123], v[160:175]
    v_mfma_f32_32x32x16_bf16 v[176:191], a[60:63], a[124:127], v[176:191]
    s_waitcnt lgkmcnt(1)
    v_pk_mul_f32 v[16:17], v[16:17], v[208:209] op_sel_hi:[1,0]
    v_pk_mul_f32 v[18:19], v[18:19], v[208:209] op_sel_hi:[1,0]
    v_pk_mul_f32 v[32:33], v[32:33], v[208:209] op_sel_hi:[1,0]
    v_pk_mul_f32 v[34:35], v[34:35], v[208:209] op_sel_hi:[1,0]
    v_pk_mul_f32 v[80:81], v[16:17], v[192:193]
    v_pk_mul_f32 v[84:85], v[32:33], v[192:193]
    v_pk_mul_f32 v[82:83], v[18:19], v[194:195]
    v_pk_mul_f32 v[86:87], v[34:35], v[194:195]
    v_pk_fma_f32 v[80:81], v[32:33], v[196:197], v[80:81]
    v_pk_fma_f32 v[84:85], v[16:17], v[196:197], v[84:85] neg_lo:[1,0,0] neg_hi:[1,0,0]
    v_pk_fma_f32 v[82:83], v[34:35], v[198:199], v[82:83]
    v_pk_fma_f32 v[86:87], v[18:19], v[198:199], v[86:87] neg_lo:[1,0,0] neg_hi:[1,0,0]
    v_pk_add_f32 v[232:233], v[80:81], v[82:83]
    v_pk_add_f32 v[234:235], v[80:81], v[82:83] neg_lo:[0,1] neg_hi:[0,1]
    v_pk_add_f32 v[236:237], v[84:85], v[86:87]
    v_pk_add_f32 v[238:239], v[84:85], v[86:87] neg_lo:[0,1] neg_hi:[0,1]
    v_add_f32 v96, v232, v233
    v_add_f32 v98, v236, v237
    v_sub_f32 v100, v232, v233
    v_sub_f32 v102, v237, v236
    v_add_f32 v104, v234, v239
    v_sub_f32 v106, v238, v235
    v_sub_f32 v108, v234, v239
    v_sub_f32 v110, -v238, v235
    s_mov_b32 exec_lo, 1
    s_mov_b32 exec_hi, 1
    v_pk_add_f32 v[232:233], v[16:17], v[18:19]
    v_pk_add_f32 v[234:235], v[16:17], v[18:19] neg_lo:[0,1] neg_hi:[0,1]
    v_add_f32 v236, v33, v35
    v_sub_f32 v237, v33, v35
    v_sub_f32 v100, v232, v233
    v_mov_b32 v104, v234
    v_mul_f32 v106, -1.0, v235
    v_fma_f32 v96, v237, s0, v32
    v_fma_f32 v98, -v236, s0, -v34
    v_fma_f32 v108, -v237, s0, v32
    v_fma_f32 v110, -v236, s0, v34
    s_mov_b64 exec, -1
    v_pk_mul_f32 v[20:21], v[20:21], v[208:209] op_sel:[0,1]
    v_pk_mul_f32 v[22:23], v[22:23], v[208:209] op_sel:[0,1]
    v_pk_mul_f32 v[36:37], v[36:37], v[208:209] op_sel:[0,1]
    v_pk_mul_f32 v[38:39], v[38:39], v[208:209] op_sel:[0,1]
    v_pk_mul_f32 v[88:89], v[20:21], v[192:193]
    v_pk_mul_f32 v[92:93], v[36:37], v[192:193]
    v_pk_mul_f32 v[90:91], v[22:23], v[194:195]
    v_pk_mul_f32 v[94:95], v[38:39], v[194:195]
    v_pk_fma_f32 v[88:89], v[36:37], v[196:197], v[88:89]
    v_pk_fma_f32 v[92:93], v[20:21], v[196:197], v[92:93] neg_lo:[1,0,0] neg_hi:[1,0,0]
    v_pk_fma_f32 v[90:91], v[38:39], v[198:199], v[90:91]
    v_pk_fma_f32 v[94:95], v[22:23], v[198:199], v[94:95] neg_lo:[1,0,0] neg_hi:[1,0,0]
    v_pk_add_f32 v[232:233], v[88:89], v[90:91]
    v_pk_add_f32 v[234:235], v[88:89], v[90:91] neg_lo:[0,1] neg_hi:[0,1]
    v_pk_add_f32 v[236:237], v[92:93], v[94:95]
    v_pk_add_f32 v[238:239], v[92:93], v[94:95] neg_lo:[0,1] neg_hi:[0,1]
    v_add_f32 v97, v232, v233
    v_add_f32 v99, v236, v237
    v_sub_f32 v101, v232, v233
    v_sub_f32 v103, v237, v236
    v_add_f32 v105, v234, v239
    v_sub_f32 v107, v238, v235
    v_sub_f32 v109, v234, v239
    v_sub_f32 v111, -v238, v235
    s_mov_b32 exec_lo, 1
    s_mov_b32 exec_hi, 1
    v_pk_add_f32 v[232:233], v[20:21], v[22:23]
    v_pk_add_f32 v[234:235], v[20:21], v[22:23] neg_lo:[0,1] neg_hi:[0,1]
    v_add_f32 v236, v37, v39
    v_sub_f32 v237, v37, v39
    v_sub_f32 v101, v232, v233
    v_mov_b32 v105, v234
    v_mul_f32 v107, -1.0, v235
    v_fma_f32 v97, v237, s0, v36
    v_fma_f32 v99, -v236, s0, -v38
    v_fma_f32 v109, -v237, s0, v36
    v_fma_f32 v111, -v236, s0, v38
    s_mov_b64 exec, -1
    v_cvt_pk_bf16_f32 v112, v96, v97
    v_cvt_pk_bf16_f32 v114, v98, v99
    v_cvt_pk_bf16_f32 v116, v100, v101
    v_cvt_pk_bf16_f32 v118, v102, v103
    v_cvt_pk_bf16_f32 v120, v104, v105
    v_cvt_pk_bf16_f32 v122, v106, v107
    v_cvt_pk_bf16_f32 v124, v108, v109
    v_cvt_pk_bf16_f32 v126, v110, v111
    v_pk_mul_f32 v[24:25], v[24:25], v[210:211] op_sel_hi:[1,0]
    v_pk_mul_f32 v[26:27], v[26:27], v[210:211] op_sel_hi:[1,0]
    v_pk_mul_f32 v[40:41], v[40:41], v[210:211] op_sel_hi:[1,0]
    v_pk_mul_f32 v[42:43], v[42:43], v[210:211] op_sel_hi:[1,0]
    v_pk_mul_f32 v[80:81], v[24:25], v[192:193]
    v_pk_mul_f32 v[84:85], v[40:41], v[192:193]
    v_pk_mul_f32 v[82:83], v[26:27], v[194:195]
    v_pk_mul_f32 v[86:87], v[42:43], v[194:195]
    v_pk_fma_f32 v[80:81], v[40:41], v[196:197], v[80:81]
    v_pk_fma_f32 v[84:85], v[24:25], v[196:197], v[84:85] neg_lo:[1,0,0] neg_hi:[1,0,0]
    v_pk_fma_f32 v[82:83], v[42:43], v[198:199], v[82:83]
    v_pk_fma_f32 v[86:87], v[26:27], v[198:199], v[86:87] neg_lo:[1,0,0] neg_hi:[1,0,0]
    v_pk_add_f32 v[232:233], v[80:81], v[82:83]
    v_pk_add_f32 v[234:235], v[80:81], v[82:83] neg_lo:[0,1] neg_hi:[0,1]
    v_pk_add_f32 v[236:237], v[84:85], v[86:87]
    v_pk_add_f32 v[238:239], v[84:85], v[86:87] neg_lo:[0,1] neg_hi:[0,1]
    v_add_f32 v96, v232, v233
    v_add_f32 v98, v236, v237
    v_sub_f32 v100, v232, v233
    v_sub_f32 v102, v237, v236
    v_add_f32 v104, v234, v239
    v_sub_f32 v106, v238, v235
    v_sub_f32 v108, v234, v239
    v_sub_f32 v110, -v238, v235
    s_mov_b32 exec_lo, 1
    s_mov_b32 exec_hi, 1
    v_pk_add_f32 v[232:233], v[24:25], v[26:27]
    v_pk_add_f32 v[234:235], v[24:25], v[26:27] neg_lo:[0,1] neg_hi:[0,1]
    v_add_f32 v236, v41, v43
    v_sub_f32 v237, v41, v43
    v_sub_f32 v100, v232, v233
    v_mov_b32 v104, v234
    v_mul_f32 v106, -1.0, v235
    v_fma_f32 v96, v237, s0, v40
    v_fma_f32 v98, -v236, s0, -v42
    v_fma_f32 v108, -v237, s0, v40
    v_fma_f32 v110, -v236, s0, v42
    s_mov_b64 exec, -1
    v_pk_mul_f32 v[28:29], v[28:29], v[210:211] op_sel:[0,1]
    v_pk_mul_f32 v[30:31], v[30:31], v[210:211] op_sel:[0,1]
    v_pk_mul_f32 v[44:45], v[44:45], v[210:211] op_sel:[0,1]
    v_pk_mul_f32 v[46:47], v[46:47], v[210:211] op_sel:[0,1]
    v_pk_mul_f32 v[88:89], v[28:29], v[192:193]
    v_pk_mul_f32 v[92:93], v[44:45], v[192:193]
    v_pk_mul_f32 v[90:91], v[30:31], v[194:195]
    v_pk_mul_f32 v[94:95], v[46:47], v[194:195]
    v_pk_fma_f32 v[88:89], v[44:45], v[196:197], v[88:89]
    v_pk_fma_f32 v[92:93], v[28:29], v[196:197], v[92:93] neg_lo:[1,0,0] neg_hi:[1,0,0]
    v_pk_fma_f32 v[90:91], v[46:47], v[198:199], v[90:91]
    v_pk_fma_f32 v[94:95], v[30:31], v[198:199], v[94:95] neg_lo:[1,0,0] neg_hi:[1,0,0]
    v_pk_add_f32 v[232:233], v[88:89], v[90:91]
    v_pk_add_f32 v[234:235], v[88:89], v[90:91] neg_lo:[0,1] neg_hi:[0,1]
    v_pk_add_f32 v[236:237], v[92:93], v[94:95]
    v_pk_add_f32 v[238:239], v[92:93], v[94:95] neg_lo:[0,1] neg_hi:[0,1]
    v_add_f32 v97, v232, v233
    v_add_f32 v99, v236, v237
    v_sub_f32 v101, v232, v233
    v_sub_f32 v103, v237, v236
    v_add_f32 v105, v234, v239
    v_sub_f32 v107, v238, v235
    v_sub_f32 v109, v234, v239
    v_sub_f32 v111, -v238, v235
    s_mov_b32 exec_lo, 1
    s_mov_b32 exec_hi, 1
    v_pk_add_f32 v[232:233], v[28:29], v[30:31]
    v_pk_add_f32 v[234:235], v[28:29], v[30:31] neg_lo:[0,1] neg_hi:[0,1]
    v_add_f32 v236, v45, v47
    v_sub_f32 v237, v45, v47
    v_sub_f32 v101, v232, v233
    v_mov_b32 v105, v234
    v_mul_f32 v107, -1.0, v235
    v_fma_f32 v97, v237, s0, v44
    v_fma_f32 v99, -v236, s0, -v46
    v_fma_f32 v109, -v237, s0, v44
    v_fma_f32 v111, -v236, s0, v46
    s_mov_b64 exec, -1
    v_cvt_pk_bf16_f32 v113, v96, v97
    v_cvt_pk_bf16_f32 v115, v98, v99
    v_cvt_pk_bf16_f32 v117, v100, v101
    v_cvt_pk_bf16_f32 v119, v102, v103
    v_cvt_pk_bf16_f32 v121, v104, v105
    v_cvt_pk_bf16_f32 v123, v106, v107
    v_cvt_pk_bf16_f32 v125, v108, v109
    v_cvt_pk_bf16_f32 v127, v110, v111
    ds_write_b64 v4, v[112:113] offset:0
    ds_write_b64 v4, v[114:115] offset:4608
    ds_write_b64 v4, v[116:117] offset:9216
    ds_write_b64 v4, v[118:119] offset:13824
    ds_write_b64 v4, v[120:121] offset:18432
    ds_write_b64 v4, v[122:123] offset:23040
    ds_write_b64 v4, v[124:125] offset:27648
    ds_write_b64 v4, v[126:127] offset:32256
    s_waitcnt lgkmcnt(8)
    v_pk_mul_f32 v[48:49], v[48:49], v[212:213] op_sel_hi:[1,0]
    v_pk_mul_f32 v[50:51], v[50:51], v[212:213] op_sel_hi:[1,0]
    v_pk_mul_f32 v[64:65], v[64:65], v[212:213] op_sel_hi:[1,0]
    v_pk_mul_f32 v[66:67], v[66:67], v[212:213] op_sel_hi:[1,0]
    v_pk_mul_f32 v[80:81], v[48:49], v[192:193]
    v_pk_mul_f32 v[84:85], v[64:65], v[192:193]
    v_pk_mul_f32 v[82:83], v[50:51], v[194:195]
    v_pk_mul_f32 v[86:87], v[66:67], v[194:195]
    v_pk_fma_f32 v[80:81], v[64:65], v[196:197], v[80:81]
    v_pk_fma_f32 v[84:85], v[48:49], v[196:197], v[84:85] neg_lo:[1,0,0] neg_hi:[1,0,0]
    v_pk_fma_f32 v[82:83], v[66:67], v[198:199], v[82:83]
    v_pk_fma_f32 v[86:87], v[50:51], v[198:199], v[86:87] neg_lo:[1,0,0] neg_hi:[1,0,0]
    v_pk_add_f32 v[232:233], v[80:81], v[82:83]
    v_pk_add_f32 v[234:235], v[80:81], v[82:83] neg_lo:[0,1] neg_hi:[0,1]
    v_pk_add_f32 v[236:237], v[84:85], v[86:87]
    v_pk_add_f32 v[238:239], v[84:85], v[86:87] neg_lo:[0,1] neg_hi:[0,1]
    v_add_f32 v96, v232, v233
    v_add_f32 v98, v236, v237
    v_sub_f32 v100, v232, v233
    v_sub_f32 v102, v237, v236
    v_add_f32 v104, v234, v239
    v_sub_f32 v106, v238, v235
    v_sub_f32 v108, v234, v239
    v_sub_f32 v110, -v238, v235
    s_mov_b32 exec_lo, 1
    s_mov_b32 exec_hi, 1
    v_pk_add_f32 v[232:233], v[48:49], v[50:51]
    v_pk_add_f32 v[234:235], v[48:49], v[50:51] neg_lo:[0,1] neg_hi:[0,1]
    v_add_f32 v236, v65, v67
    v_sub_f32 v237, v65, v67
    v_sub_f32 v100, v232, v233
    v_mov_b32 v104, v234
    v_mul_f32 v106, -1.0, v235
    v_fma_f32 v96, v237, s0, v64
    v_fma_f32 v98, -v236, s0, -v66
    v_fma_f32 v108, -v237, s0, v64
    v_fma_f32 v110, -v236, s0, v66
    s_mov_b64 exec, -1
    v_pk_mul_f32 v[52:53], v[52:53], v[212:213] op_sel:[0,1]
    v_pk_mul_f32 v[54:55], v[54:55], v[212:213] op_sel:[0,1]
    v_pk_mul_f32 v[68:69], v[68:69], v[212:213] op_sel:[0,1]
    v_pk_mul_f32 v[70:71], v[70:71], v[212:213] op_sel:[0,1]
    v_pk_mul_f32 v[88:89], v[52:53], v[192:193]
    v_pk_mul_f32 v[92:93], v[68:69], v[192:193]
    v_pk_mul_f32 v[90:91], v[54:55], v[194:195]
    v_pk_mul_f32 v[94:95], v[70:71], v[194:195]
    v_pk_fma_f32 v[88:89], v[68:69], v[196:197], v[88:89]
    v_pk_fma_f32 v[92:93], v[52:53], v[196:197], v[92:93] neg_lo:[1,0,0] neg_hi:[1,0,0]
    v_pk_fma_f32 v[90:91], v[70:71], v[198:199], v[90:91]
    v_pk_fma_f32 v[94:95], v[54:55], v[198:199], v[94:95] neg_lo:[1,0,0] neg_hi:[1,0,0]
    v_pk_add_f32 v[232:233], v[88:89], v[90:91]
    v_pk_add_f32 v[234:235], v[88:89], v[90:91] neg_lo:[0,1] neg_hi:[0,1]
    v_pk_add_f32 v[236:237], v[92:93], v[94:95]
    v_pk_add_f32 v[238:239], v[92:93], v[94:95] neg_lo:[0,1] neg_hi:[0,1]
    v_add_f32 v97, v232, v233
    v_add_f32 v99, v236, v237
    v_sub_f32 v101, v232, v233
    v_sub_f32 v103, v237, v236
    v_add_f32 v105, v234, v239
    v_sub_f32 v107, v238, v235
    v_sub_f32 v109, v234, v239
    v_sub_f32 v111, -v238, v235
    s_mov_b32 exec_lo, 1
    s_mov_b32 exec_hi, 1
    v_pk_add_f32 v[232:233], v[52:53], v[54:55]
    v_pk_add_f32 v[234:235], v[52:53], v[54:55] neg_lo:[0,1] neg_hi:[0,1]
    v_add_f32 v236, v69, v71
    v_sub_f32 v237, v69, v71
    v_sub_f32 v101, v232, v233
    v_mov_b32 v105, v234
    v_mul_f32 v107, -1.0, v235
    v_fma_f32 v97, v237, s0, v68
    v_fma_f32 v99, -v236, s0, -v70
    v_fma_f32 v109, -v237, s0, v68
    v_fma_f32 v111, -v236, s0, v70
    s_mov_b64 exec, -1
    v_cvt_pk_bf16_f32 v112, v96, v97
    v_cvt_pk_bf16_f32 v114, v98, v99
    v_cvt_pk_bf16_f32 v116, v100, v101
    v_cvt_pk_bf16_f32 v118, v102, v103
    v_cvt_pk_bf16_f32 v120, v104, v105
    v_cvt_pk_bf16_f32 v122, v106, v107
    v_cvt_pk_bf16_f32 v124, v108, v109
    v_cvt_pk_bf16_f32 v126, v110, v111
    v_pk_mul_f32 v[56:57], v[56:57], v[214:215] op_sel_hi:[1,0]
    v_pk_mul_f32 v[58:59], v[58:59], v[214:215] op_sel_hi:[1,0]
    v_pk_mul_f32 v[72:73], v[72:73], v[214:215] op_sel_hi:[1,0]
    v_pk_mul_f32 v[74:75], v[74:75], v[214:215] op_sel_hi:[1,0]
    v_pk_mul_f32 v[80:81], v[56:57], v[192:193]
    v_pk_mul_f32 v[84:85], v[72:73], v[192:193]
    v_pk_mul_f32 v[82:83], v[58:59], v[194:195]
    v_pk_mul_f32 v[86:87], v[74:75], v[194:195]
    v_pk_fma_f32 v[80:81], v[72:73], v[196:197], v[80:81]
    v_pk_fma_f32 v[84:85], v[56:57], v[196:197], v[84:85] neg_lo:[1,0,0] neg_hi:[1,0,0]
    v_pk_fma_f32 v[82:83], v[74:75], v[198:199], v[82:83]
    v_pk_fma_f32 v[86:87], v[58:59], v[198:199], v[86:87] neg_lo:[1,0,0] neg_hi:[1,0,0]
    v_pk_add_f32 v[232:233], v[80:81], v[82:83]
    v_pk_add_f32 v[234:235], v[80:81], v[82:83] neg_lo:[0,1] neg_hi:[0,1]
    v_pk_add_f32 v[236:237], v[84:85], v[86:87]
    v_pk_add_f32 v[238:239], v[84:85], v[86:87] neg_lo:[0,1] neg_hi:[0,1]
    v_add_f32 v96, v232, v233
    v_add_f32 v98, v236, v237
    v_sub_f32 v100, v232, v233
    v_sub_f32 v102, v237, v236
    v_add_f32 v104, v234, v239
    v_sub_f32 v106, v238, v235
    v_sub_f32 v108, v234, v239
    v_sub_f32 v110, -v238, v235
    s_mov_b32 exec_lo, 1
    s_mov_b32 exec_hi, 1
    v_pk_add_f32 v[232:233], v[56:57], v[58:59]
    v_pk_add_f32 v[234:235], v[56:57], v[58:59] neg_lo:[0,1] neg_hi:[0,1]
    v_add_f32 v236, v73, v75
    v_sub_f32 v237, v73, v75
    v_sub_f32 v100, v232, v233
    v_mov_b32 v104, v234
    v_mul_f32 v106, -1.0, v235
    v_fma_f32 v96, v237, s0, v72
    v_fma_f32 v98, -v236, s0, -v74
    v_fma_f32 v108, -v237, s0, v72
    v_fma_f32 v110, -v236, s0, v74
    s_mov_b64 exec, -1
    v_pk_mul_f32 v[60:61], v[60:61], v[214:215] op_sel:[0,1]
    v_pk_mul_f32 v[62:63], v[62:63], v[214:215] op_sel:[0,1]
    v_pk_mul_f32 v[76:77], v[76:77], v[214:215] op_sel:[0,1]
    v_pk_mul_f32 v[78:79], v[78:79], v[214:215] op_sel:[0,1]
    v_pk_mul_f32 v[88:89], v[60:61], v[192:193]
    v_pk_mul_f32 v[92:93], v[76:77], v[192:193]
    v_pk_mul_f32 v[90:91], v[62:63], v[194:195]
    v_pk_mul_f32 v[94:95], v[78:79], v[194:195]
    v_pk_fma_f32 v[88:89], v[76:77], v[196:197], v[88:89]
    v_pk_fma_f32 v[92:93], v[60:61], v[196:197], v[92:93] neg_lo:[1,0,0] neg_hi:[1,0,0]
    v_pk_fma_f32 v[90:91], v[78:79], v[198:199], v[90:91]
    v_pk_fma_f32 v[94:95], v[62:63], v[198:199], v[94:95] neg_lo:[1,0,0] neg_hi:[1,0,0]
    v_pk_add_f32 v[232:233], v[88:89], v[90:91]
    v_pk_add_f32 v[234:235], v[88:89], v[90:91] neg_lo:[0,1] neg_hi:[0,1]
    v_pk_add_f32 v[236:237], v[92:93], v[94:95]
    v_pk_add_f32 v[238:239], v[92:93], v[94:95] neg_lo:[0,1] neg_hi:[0,1]
    v_add_f32 v97, v232, v233
    v_add_f32 v99, v236, v237
    v_sub_f32 v101, v232, v233
    v_sub_f32 v103, v237, v236
    v_add_f32 v105, v234, v239
    v_sub_f32 v107, v238, v235
    v_sub_f32 v109, v234, v239
    v_sub_f32 v111, -v238, v235
    s_mov_b32 exec_lo, 1
    s_mov_b32 exec_hi, 1
    v_pk_add_f32 v[232:233], v[60:61], v[62:63]
    v_pk_add_f32 v[234:235], v[60:61], v[62:63] neg_lo:[0,1] neg_hi:[0,1]
    v_add_f32 v236, v77, v79
    v_sub_f32 v237, v77, v79
    v_sub_f32 v101, v232, v233
    v_mov_b32 v105, v234
    v_mul_f32 v107, -1.0, v235
    v_fma_f32 v97, v237, s0, v76
    v_fma_f32 v99, -v236, s0, -v78
    v_fma_f32 v109, -v237, s0, v76
    v_fma_f32 v111, -v236, s0, v78
    s_mov_b64 exec, -1
    v_cvt_pk_bf16_f32 v113, v96, v97
    v_cvt_pk_bf16_f32 v115, v98, v99
    v_cvt_pk_bf16_f32 v117, v100, v101
    v_cvt_pk_bf16_f32 v119, v102, v103
    v_cvt_pk_bf16_f32 v121, v104, v105
    v_cvt_pk_bf16_f32 v123, v106, v107
    v_cvt_pk_bf16_f32 v125, v108, v109
    v_cvt_pk_bf16_f32 v127, v110, v111
    ds_write_b64 v4, v[112:113] offset:16
    ds_write_b64 v4, v[114:115] offset:4624
    ds_write_b64 v4, v[116:117] offset:9232
    ds_write_b64 v4, v[118:119] offset:13840
    ds_write_b64 v4, v[120:121] offset:18448
    ds_write_b64 v4, v[122:123] offset:23056
    ds_write_b64 v4, v[124:125] offset:27664
    ds_write_b64 v4, v[126:127] offset:32272
    v_add_u32 v4, 36864, v4
    s_waitcnt lgkmcnt(0)
    s_barrier
    ds_read_b128 v[16:19], v5 offset:0
    ds_read_b128 v[20:23], v5 offset:1152
    ds_read_b128 v[24:27], v5 offset:2304
    ds_read_b128 v[28:31], v5 offset:3456
    ds_read_b128 v[32:35], v5 offset:4608
    ds_read_b128 v[36:39], v5 offset:5760
    ds_read_b128 v[40:43], v5 offset:6912
    ds_read_b128 v[44:47], v5 offset:8064
    v_pk_mul_f32 v[128:129], v[128:129], v[208:209] op_sel_hi:[1,0]
    v_pk_mul_f32 v[130:131], v[130:131], v[208:209] op_sel_hi:[1,0]
    v_pk_mul_f32 v[144:145], v[144:145], v[208:209] op_sel_hi:[1,0]
    v_pk_mul_f32 v[146:147], v[146:147], v[208:209] op_sel_hi:[1,0]
    v_pk_mul_f32 v[80:81], v[128:129], v[200:201]
    v_pk_mul_f32 v[84:85], v[144:145], v[200:201]
    v_pk_mul_f32 v[82:83], v[130:131], v[202:203]
    v_pk_mul_f32 v[86:87], v[146:147], v[202:203]
    v_pk_fma_f32 v[80:81], v[144:145], v[204:205], v[80:81]
    v_pk_fma_f32 v[84:85], v[128:129], v[204:205], v[84:85] neg_lo:[1,0,0] neg_hi:[1,0,0]
    v_pk_fma_f32 v[82:83], v[146:147], v[206:207], v[82:83]
    v_pk_fma_f32 v[86:87], v[130:131], v[206:207], v[86:87] neg_lo:[1,0,0] neg_hi:[1,0,0]
    v_pk_add_f32 v[232:233], v[80:81], v[82:83]
    s_mul_i32 s56, s78, 0
    s_add_u32 s56, s56, s77
    s_waitcnt lgkmcnt(7)
    buffer_store_dwordx4 v[16:19], v12, s[36:39], s56 offen sc1
    v_pk_add_f32 v[234:235], v[80:81], v[82:83] neg_lo:[0,1] neg_hi:[0,1]
    v_pk_add_f32 v[236:237], v[84:85], v[86:87]
    v_pk_add_f32 v[238:239], v[84:85], v[86:87] neg_lo:[0,1] neg_hi:[0,1]
    v_add_f32 v96, v232, v233
    v_add_f32 v98, v236, v237
    v_sub_f32 v100, v232, v233
    v_sub_f32 v102, v237, v236
    v_add_f32 v104, v234, v239
    v_sub_f32 v106, v238, v235
    v_sub_f32 v108, v234, v239
    v_sub_f32 v110, -v238, v235
    v_pk_mul_f32 v[132:133], v[132:133], v[208:209] op_sel:[0,1]
    v_pk_mul_f32 v[134:135], v[134:135], v[208:209] op_sel:[0,1]
    v_pk_mul_f32 v[148:149], v[148:149], v[208:209] op_sel:[0,1]
    v_pk_mul_f32 v[150:151], v[150:151], v[208:209] op_sel:[0,1]
    v_pk_mul_f32 v[88:89], v[132:133], v[200:201]
    v_pk_mul_f32 v[92:93], v[148:149], v[200:201]
    v_pk_mul_f32 v[90:91], v[134:135], v[202:203]
    v_pk_mul_f32 v[94:95], v[150:151], v[202:203]
    v_pk_fma_f32 v[88:89], v[148:149], v[204:205], v[88:89]
    v_pk_fma_f32 v[92:93], v[132:133], v[204:205], v[92:93] neg_lo:[1,0,0] neg_hi:[1,0,0]
    v_pk_fma_f32 v[90:91], v[150:151], v[206:207], v[90:91]
    v_pk_fma_f32 v[94:95], v[134:135], v[206:207], v[94:95] neg_lo:[1,0,0] neg_hi:[1,0,0]
    v_pk_add_f32 v[232:233], v[88:89], v[90:91]
    s_mul_i32 s56, s78, 1
    s_add_u32 s56, s56, s77
    s_waitcnt lgkmcnt(6)
    buffer_store_dwordx4 v[20:23], v7, s[36:39], s56 offen sc1
    v_pk_add_f32 v[234:235], v[88:89], v[90:91] neg_lo:[0,1] neg_hi:[0,1]
    v_pk_add_f32 v[236:237], v[92:93], v[94:95]
    v_pk_add_f32 v[238:239], v[92:93], v[94:95] neg_lo:[0,1] neg_hi:[0,1]
    v_add_f32 v97, v232, v233
    v_add_f32 v99, v236, v237
    v_sub_f32 v101, v232, v233
    v_sub_f32 v103, v237, v236
    v_add_f32 v105, v234, v239
    v_sub_f32 v107, v238, v235
    v_sub_f32 v109, v234, v239
    v_sub_f32 v111, -v238, v235
    v_cvt_pk_bf16_f32 v112, v96, v97
    v_cvt_pk_bf16_f32 v114, v98, v99
    v_cvt_pk_bf16_f32 v116, v100, v101
    v_cvt_pk_bf16_f32 v118, v102, v103
    v_cvt_pk_bf16_f32 v120, v104, v105
    v_cvt_pk_bf16_f32 v122, v106, v107
    v_cvt_pk_bf16_f32 v124, v108, v109
    v_cvt_pk_bf16_f32 v126, v110, v111
    v_pk_mul_f32 v[136:137], v[136:137], v[210:211] op_sel_hi:[1,0]
    v_pk_mul_f32 v[138:139], v[138:139], v[210:211] op_sel_hi:[1,0]
    v_pk_mul_f32 v[152:153], v[152:153], v[210:211] op_sel_hi:[1,0]
    v_pk_mul_f32 v[154:155], v[154:155], v[210:211] op_sel_hi:[1,0]
    v_pk_mul_f32 v[80:81], v[136:137], v[200:201]
    s_mul_i32 s56, s78, 2
    s_add_u32 s56, s56, s77
    s_waitcnt lgkmcnt(5)
    buffer_store_dwordx4 v[24:27], v7, s[36:39], s56 offen sc1
    v_pk_mul_f32 v[84:85], v[152:153], v[200:201]
    v_pk_mul_f32 v[82:83], v[138:139], v[202:203]
    v_pk_mul_f32 v[86:87], v[154:155], v[202:203]
    v_pk_fma_f32 v[80:81], v[152:153], v[204:205], v[80:81]
    v_pk_fma_f32 v[84:85], v[136:137], v[204:205], v[84:85] neg_lo:[1,0,0] neg_hi:[1,0,0]
    v_pk_fma_f32 v[82:83], v[154:155], v[206:207], v[82:83]
    v_pk_fma_f32 v[86:87], v[138:139], v[206:207], v[86:87] neg_lo:[1,0,0] neg_hi:[1,0,0]
    v_pk_add_f32 v[232:233], v[80:81], v[82:83]
    v_pk_add_f32 v[234:235], v[80:81], v[82:83] neg_lo:[0,1] neg_hi:[0,1]
    v_pk_add_f32 v[236:237], v[84:85], v[86:87]
    v_pk_add_f32 v[238:239], v[84:85], v[86:87] neg_lo:[0,1] neg_hi:[0,1]
    v_add_f32 v96, v232, v233
    v_add_f32 v98, v236, v237
    v_sub_f32 v100, v232, v233
    v_sub_f32 v102, v237, v236
    v_add_f32 v104, v234, v239
    v_sub_f32 v106, v238, v235
    v_sub_f32 v108, v234, v239
    v_sub_f32 v110, -v238, v235
    v_pk_mul_f32 v[140:141], v[140:141], v[210:211] op_sel:[0,1]
    v_pk_mul_f32 v[142:143], v[142:143], v[210:211] op_sel:[0,1]
    v_pk_mul_f32 v[156:157], v[156:157], v[210:211] op_sel:[0,1]
    v_pk_mul_f32 v[158:159], v[158:159], v[210:211] op_sel:[0,1]
    v_pk_mul_f32 v[88:89], v[140:141], v[200:201]
    v_pk_mul_f32 v[92:93], v[156:157], v[200:201]
    s_mul_i32 s56, s78, 3
    s_add_u32 s56, s56, s77
    s_waitcnt lgkmcnt(4)
    buffer_store_dwordx4 v[28:31], v7, s[36:39], s56 offen sc1
    v_pk_mul_f32 v[90:91], v[142:143], v[202:203]
    v_pk_mul_f32 v[94:95], v[158:159], v[202:203]
    v_pk_fma_f32 v[88:89], v[156:157], v[204:205], v[88:89]
    v_pk_fma_f32 v[92:93], v[140:141], v[204:205], v[92:93] neg_lo:[1,0,0] neg_hi:[1,0,0]
    v_pk_fma_f32 v[90:91], v[158:159], v[206:207], v[90:91]
    v_pk_fma_f32 v[94:95], v[142:143], v[206:207], v[94:95] neg_lo:[1,0,0] neg_hi:[1,0,0]
    v_pk_add_f32 v[232:233], v[88:89], v[90:91]
    v_pk_add_f32 v[234:235], v[88:89], v[90:91] neg_lo:[0,1] neg_hi:[0,1]
    v_pk_add_f32 v[236:237], v[92:93], v[94:95]
    v_pk_add_f32 v[238:239], v[92:93], v[94:95] neg_lo:[0,1] neg_hi:[0,1]
    v_add_f32 v97, v232, v233
    v_add_f32 v99, v236, v237
    v_sub_f32 v101, v232, v233
    v_sub_f32 v103, v237, v236
    v_add_f32 v105, v234, v239
    v_sub_f32 v107, v238, v235
    v_sub_f32 v109, v234, v239
    v_sub_f32 v111, -v238, v235
    v_cvt_pk_bf16_f32 v113, v96, v97
    v_cvt_pk_bf16_f32 v115, v98, v99
    v_cvt_pk_bf16_f32 v117, v100, v101
    v_cvt_pk_bf16_f32 v119, v102, v103
    v_cvt_pk_bf16_f32 v121, v104, v105
    v_cvt_pk_bf16_f32 v123, v106, v107
    s_mul_i32 s56, s78, 0
    s_add_u32 s56, s56, s77
    s_add_u32 s56, s56, 4096
    s_waitcnt lgkmcnt(3)
    buffer_store_dwordx4 v[32:35], v12, s[36:39], s56 offen sc1
    v_cvt_pk_bf16_f32 v125, v108, v109
    v_cvt_pk_bf16_f32 v127, v110, v111
    ds_write_b64 v4, v[112:113] offset:0
    ds_write_b64 v4, v[114:115] offset:4608
    ds_write_b64 v4, v[116:117] offset:9216
    ds_write_b64 v4, v[118:119] offset:13824
    ds_write_b64 v4, v[120:121] offset:18432
    ds_write_b64 v4, v[122:123] offset:23040
    ds_write_b64 v4, v[124:125] offset:27648
    ds_write_b64 v4, v[126:127] offset:32256
    v_pk_mul_f32 v[160:161], v[160:161], v[212:213] op_sel_hi:[1,0]
    v_pk_mul_f32 v[162:163], v[162:163], v[212:213] op_sel_hi:[1,0]
    v_pk_mul_f32 v[176:177], v[176:177], v[212:213] op_sel_hi:[1,0]
    v_pk_mul_f32 v[178:179], v[178:179], v[212:213] op_sel_hi:[1,0]
    v_pk_mul_f32 v[80:81], v[160:161], v[200:201]
    v_pk_mul_f32 v[84:85], v[176:177], v[200:201]
    v_pk_mul_f32 v[82:83], v[162:163], v[202:203]
    v_pk_mul_f32 v[86:87], v[178:179], v[202:203]
    v_pk_fma_f32 v[80:81], v[176:177], v[204:205], v[80:81]
    v_pk_fma_f32 v[84:85], v[160:161], v[204:205], v[84:85] neg_lo:[1,0,0] neg_hi:[1,0,0]
    v_pk_fma_f32 v[82:83], v[178:179], v[206:207], v[82:83]
    v_pk_fma_f32 v[86:87], v[162:163], v[206:207], v[86:87] neg_lo:[1,0,0] neg_hi:[1,0,0]
    v_pk_add_f32 v[232:233], v[80:81], v[82:83]
    s_mul_i32 s56, s78, 1
    s_add_u32 s56, s56, s77
    s_add_u32 s56, s56, 4096
    s_waitcnt lgkmcnt(10)
    buffer_store_dwordx4 v[36:39], v7, s[36:39], s56 offen sc1
    v_pk_add_f32 v[234:235], v[80:81], v[82:83] neg_lo:[0,1] neg_hi:[0,1]
    v_pk_add_f32 v[236:237], v[84:85], v[86:87]
    v_pk_add_f32 v[238:239], v[84:85], v[86:87] neg_lo:[0,1] neg_hi:[0,1]
    v_add_f32 v96, v232, v233
    v_add_f32 v98, v236, v237
    v_sub_f32 v100, v232, v233
    v_sub_f32 v102, v237, v236
    v_add_f32 v104, v234, v239
    v_sub_f32 v106, v238, v235
    v_sub_f32 v108, v234, v239
    v_sub_f32 v110, -v238, v235
    v_pk_mul_f32 v[164:165], v[164:165], v[212:213] op_sel:[0,1]
    v_pk_mul_f32 v[166:167], v[166:167], v[212:213] op_sel:[0,1]
    v_pk_mul_f32 v[180:181], v[180:181], v[212:213] op_sel:[0,1]
    v_pk_mul_f32 v[182:183], v[182:183], v[212:213] op_sel:[0,1]
    v_pk_mul_f32 v[88:89], v[164:165], v[200:201]
    v_pk_mul_f32 v[92:93], v[180:181], v[200:201]
    v_pk_mul_f32 v[90:91], v[166:167], v[202:203]
    v_pk_mul_f32 v[94:95], v[182:183], v[202:203]
    v_pk_fma_f32 v[88:89], v[180:181], v[204:205], v[88:89]
    v_pk_fma_f32 v[92:93], v[164:165], v[204:205], v[92:93] neg_lo:[1,0,0] neg_hi:[1,0,0]
    v_pk_fma_f32 v[90:91], v[182:183], v[206:207], v[90:91]
    v_pk_fma_f32 v[94:95], v[166:167], v[206:207], v[94:95] neg_lo:[1,0,0] neg_hi:[1,0,0]
    v_pk_add_f32 v[232:233], v[88:89], v[90:91]
    s_mul_i32 s56, s78, 2
    s_add_u32 s56, s56, s77
    s_add_u32 s56, s56, 4096
    s_waitcnt lgkmcnt(9)
    buffer_store_dwordx4 v[40:43], v7, s[36:39], s56 offen sc1
    v_pk_add_f32 v[234:235], v[88:89], v[90:91] neg_lo:[0,1] neg_hi:[0,1]
    v_pk_add_f32 v[236:237], v[92:93], v[94:95]
    v_pk_add_f32 v[238:239], v[92:93], v[94:95] neg_lo:[0,1] neg_hi:[0,1]
    v_add_f32 v97, v232, v233
    v_add_f32 v99, v236, v237
    v_sub_f32 v101, v232, v233
    v_sub_f32 v103, v237, v236
    v_add_f32 v105, v234, v239
    v_sub_f32 v107, v238, v235
    v_sub_f32 v109, v234, v239
    v_sub_f32 v111, -v238, v235
    v_cvt_pk_bf16_f32 v112, v96, v97
    v_cvt_pk_bf16_f32 v114, v98, v99
    v_cvt_pk_bf16_f32 v116, v100, v101
    v_cvt_pk_bf16_f32 v118, v102, v103
    v_cvt_pk_bf16_f32 v120, v104, v105
    v_cvt_pk_bf16_f32 v122, v106, v107
    v_cvt_pk_bf16_f32 v124, v108, v109
    v_cvt_pk_bf16_f32 v126, v110, v111
    v_pk_mul_f32 v[168:169], v[168:169], v[214:215] op_sel_hi:[1,0]
    v_pk_mul_f32 v[170:171], v[170:171], v[214:215] op_sel_hi:[1,0]
    v_pk_mul_f32 v[184:185], v[184:185], v[214:215] op_sel_hi:[1,0]
    v_pk_mul_f32 v[186:187], v[186:187], v[214:215] op_sel_hi:[1,0]
    v_pk_mul_f32 v[80:81], v[168:169], v[200:201]
    s_mul_i32 s56, s78, 3
    s_add_u32 s56, s56, s77
    s_add_u32 s56, s56, 4096
    s_waitcnt lgkmcnt(8)
    buffer_store_dwordx4 v[44:47], v7, s[36:39], s56 offen sc1
    v_pk_mul_f32 v[84:85], v[184:185], v[200:201]
    v_pk_mul_f32 v[82:83], v[170:171], v[202:203]
    v_pk_mul_f32 v[86:87], v[186:187], v[202:203]
    v_pk_fma_f32 v[80:81], v[184:185], v[204:205], v[80:81]
    v_pk_fma_f32 v[84:85], v[168:169], v[204:205], v[84:85] neg_lo:[1,0,0] neg_hi:[1,0,0]
    v_pk_fma_f32 v[82:83], v[186:187], v[206:207], v[82:83]
    v_pk_fma_f32 v[86:87], v[170:171], v[206:207], v[86:87] neg_lo:[1,0,0] neg_hi:[1,0,0]
    v_pk_add_f32 v[232:233], v[80:81], v[82:83]
    v_pk_add_f32 v[234:235], v[80:81], v[82:83] neg_lo:[0,1] neg_hi:[0,1]
    v_pk_add_f32 v[236:237], v[84:85], v[86:87]
    v_pk_add_f32 v[238:239], v[84:85], v[86:87] neg_lo:[0,1] neg_hi:[0,1]
    v_add_f32 v96, v232, v233
    v_add_f32 v98, v236, v237
    v_sub_f32 v100, v232, v233
    v_sub_f32 v102, v237, v236
    v_add_f32 v104, v234, v239
    v_sub_f32 v106, v238, v235
    v_sub_f32 v108, v234, v239
    v_sub_f32 v110, -v238, v235
    v_pk_mul_f32 v[172:173], v[172:173], v[214:215] op_sel:[0,1]
    v_pk_mul_f32 v[174:175], v[174:175], v[214:215] op_sel:[0,1]
    v_pk_mul_f32 v[188:189], v[188:189], v[214:215] op_sel:[0,1]
    v_pk_mul_f32 v[190:191], v[190:191], v[214:215] op_sel:[0,1]
    v_pk_mul_f32 v[88:89], v[172:173], v[200:201]
    v_pk_mul_f32 v[92:93], v[188:189], v[200:201]
    s_mul_i32 s90, s3, 2304
    s_add_u32 s90, s90, 141824
    v_lshrrev_b32 v224, 3, v1
    v_and_b32 v225, 7, v1
    v_lshlrev_b32 v225, 4, v225
    v_mul_u32_u24 v240, 144, v224
    v_add3_u32 v240, v240, v225, s90
    ds_read_b128 v[216:219], v240
    ds_read_b128 v[220:223], v240 offset:1152
    v_lshl_add_u32 v224, v224, 13, v225
    s_and_b32 s90, s2, 3
    s_lshl_b32 s90, s90, 2
    s_add_u32 s90, s90, s3
    s_lshl_b32 s90, s90, 17
    s_and_b32 s91, s2, 0xfc
    s_lshl_b32 s91, s91, 5
    s_add_u32 s90, s90, s91
    s_add_u32 s90, s90, 3145728
    s_add_u32 s91, s90, 65536
    s_waitcnt lgkmcnt(1)
    buffer_store_dwordx4 v[216:219], v224, s[36:39], s90 offen sc1
    v_pk_mul_f32 v[90:91], v[174:175], v[202:203]
    v_pk_mul_f32 v[94:95], v[190:191], v[202:203]
    v_pk_fma_f32 v[88:89], v[188:189], v[204:205], v[88:89]
    v_pk_fma_f32 v[92:93], v[172:173], v[204:205], v[92:93] neg_lo:[1,0,0] neg_hi:[1,0,0]
    v_pk_fma_f32 v[90:91], v[190:191], v[206:207], v[90:91]
    v_pk_fma_f32 v[94:95], v[174:175], v[206:207], v[94:95] neg_lo:[1,0,0] neg_hi:[1,0,0]
    v_pk_add_f32 v[232:233], v[88:89], v[90:91]
    v_pk_add_f32 v[234:235], v[88:89], v[90:91] neg_lo:[0,1] neg_hi:[0,1]
    v_pk_add_f32 v[236:237], v[92:93], v[94:95]
    v_pk_add_f32 v[238:239], v[92:93], v[94:95] neg_lo:[0,1] neg_hi:[0,1]
    v_add_f32 v97, v232, v233
    v_add_f32 v99, v236, v237
    v_sub_f32 v101, v232, v233
    v_sub_f32 v103, v237, v236
    v_add_f32 v105, v234, v239
    v_sub_f32 v107, v238, v235
    v_sub_f32 v109, v234, v239
    v_sub_f32 v111, -v238, v235
    v_cvt_pk_bf16_f32 v113, v96, v97
    v_cvt_pk_bf16_f32 v115, v98, v99
    v_cvt_pk_bf16_f32 v117, v100, v101
    v_cvt_pk_bf16_f32 v119, v102, v103
    v_cvt_pk_bf16_f32 v121, v104, v105
    v_cvt_pk_bf16_f32 v123, v106, v107
    s_waitcnt lgkmcnt(0)
    buffer_store_dwordx4 v[220:223], v224, s[36:39], s91 offen sc1
    v_cvt_pk_bf16_f32 v125, v108, v109
    v_cvt_pk_bf16_f32 v127, v110, v111
    ds_write_b64 v4, v[112:113] offset:16
    ds_write_b64 v4, v[114:115] offset:4624
    ds_write_b64 v4, v[116:117] offset:9232
    ds_write_b64 v4, v[118:119] offset:13840
    ds_write_b64 v4, v[120:121] offset:18448
    ds_write_b64 v4, v[122:123] offset:23056
    ds_write_b64 v4, v[124:125] offset:27664
    ds_write_b64 v4, v[126:127] offset:32272
    s_waitcnt lgkmcnt(0)
    s_barrier
    ds_read_b128 v[48:51], v5 offset:36864
    ds_read_b128 v[52:55], v5 offset:38016
    ds_read_b128 v[56:59], v5 offset:39168
    ds_read_b128 v[60:63], v5 offset:40320
    ds_read_b128 v[64:67], v5 offset:41472
    ds_read_b128 v[68:71], v5 offset:42624
    ds_read_b128 v[72:75], v5 offset:43776
    ds_read_b128 v[76:79], v5 offset:44928
    s_mul_i32 s56, s78, 4
    s_add_u32 s56, s56, s77
    s_waitcnt lgkmcnt(7)
    buffer_store_dwordx4 v[48:51], v7, s[36:39], s56 offen sc1
    s_mul_i32 s56, s78, 5
    s_add_u32 s56, s56, s77
    s_waitcnt lgkmcnt(6)
    buffer_store_dwordx4 v[52:55], v7, s[36:39], s56 offen sc1
    s_mul_i32 s56, s78, 6
    s_add_u32 s56, s56, s77
    s_waitcnt lgkmcnt(5)
    buffer_store_dwordx4 v[56:59], v7, s[36:39], s56 offen sc1
    s_mul_i32 s56, s78, 7
    s_add_u32 s56, s56, s77
    s_waitcnt lgkmcnt(4)
    buffer_store_dwordx4 v[60:63], v7, s[36:39], s56 offen sc1
    s_mul_i32 s56, s78, 4
    s_add_u32 s56, s56, s77
    s_add_u32 s56, s56, 4096
    s_waitcnt lgkmcnt(3)
    buffer_store_dwordx4 v[64:67], v7, s[36:39], s56 offen sc1
    s_mul_i32 s56, s78, 5
    s_add_u32 s56, s56, s77
    s_add_u32 s56, s56, 4096
    s_waitcnt lgkmcnt(2)
    buffer_store_dwordx4 v[68:71], v7, s[36:39], s56 offen sc1
    s_mul_i32 s56, s78, 6
    s_add_u32 s56, s56, s77
    s_add_u32 s56, s56, 4096
    s_waitcnt lgkmcnt(1)
    buffer_store_dwordx4 v[72:75], v7, s[36:39], s56 offen sc1
    s_mul_i32 s56, s78, 7
    s_add_u32 s56, s56, s77
    s_add_u32 s56, s56, 4096
    s_waitcnt lgkmcnt(0)
    buffer_store_dwordx4 v[76:79], v7, s[36:39], s56 offen sc1
    s_lshl_b32 s56, s72, 7
    s_add_u32 s50, s56, 262144
    s_lshl_b32 s56, s3, 12
    s_add_u32 s50, s50, s56
    s_lshl_b32 s58, s3, 10
    s_add_u32 s80, s58, 262144
    s_lshr_b32 s58, s1, 4
    s_lshl_b32 s58, s58, 13
    s_add_u32 s81, s58, 524288
    v_and_b32 v172, 7, v1
    v_lshlrev_b32 v172, 7, v172
    v_lshrrev_b32 v173, 2, v0
    v_lshlrev_b32 v173, 7, v173
    v_and_b32 v184, 15, v1
    v_lshrrev_b32 v185, 4, v1
    s_lshl_b32 s58, s3, 10
    v_lshl_add_u32 v168, v184, 6, s58
    v_lshl_add_u32 v168, v185, 4, v168
    v_lshlrev_b32 v169, 5, v0
    v_and_b32 v186, 7, v184
    v_lshlrev_b32 v184, 7, v184
    v_add_u32 v184, 147456, v184
    v_xor_b32 v171, v185, v186
    v_lshl_add_u32 v171, v171, 4, v184
    v_lshrrev_b32 v170, 1, v185
    s_lshl_b32 s58, s3, 1
    v_add_u32 v170, s58, v170
    v_xor_b32 v170, v170, v186
    v_lshl_add_u32 v170, v170, 4, v184
    v_and_b32 v185, 1, v185
    v_lshl_add_u32 v170, v185, 3, v170
    s_lshl_b32 s51, s41, 2
    s_lshr_b32 s58, s42, 3
    s_add_u32 s51, s51, s58
    s_lshl_b32 s51, s51, 1
    s_lshl_b32 s82, s3, 12
    s_mul_i32 s83, s3, 458752
    v_lshrrev_b32 v184, 3, v1
    v_and_b32 v185, 7, v1
    v_and_b32 v186, 2, v184
    v_lshlrev_b32 v186, 1, v186
    v_xor_b32 v185, v185, v186
    v_lshlrev_b32 v185, 4, v185
    v_lshl_add_u32 v174, v184, 10, v185
    s_lshl_b32 s58, s52, 7
    v_add_u32 v174, s58, v174
    v_add_u32 v175, 7168, v174
    v_add_u32 v176, 14336, v174
    v_add_u32 v177, 21504, v174
    v_and_b32 v184, 1, v1
    v_lshlrev_b32 v184, 2, v184
    v_bfe_u32 v185, v1, 4, 1
    v_lshl_or_b32 v184, v185, 1, v184
    v_bfe_u32 v185, v1, 1, 1
    v_or_b32 v184, v184, v185
    v_lshlrev_b32 v184, 3, v184
    v_bfe_u32 v185, v1, 3, 1
    v_lshl_or_b32 v184, v185, 6, v184
    v_bfe_u32 v185, v1, 2, 2
    v_lshl_or_b32 v184, v185, 7, v184
    v_lshrrev_b32 v185, 5, v1
    v_lshl_or_b32 v184, v185, 10, v184
    s_and_b32 s58, s3, 1
    s_lshl_b32 s58, s58, 6
    v_xor_b32 v178, s58, v184
    v_xor_b32 v179, 64, v178
    s_lshl_b32 s58, s3, 12
    s_add_u32 s48, s58, 147456
    v_add_u32 v180, s48, v178
    v_add_u32 v181, s48, v179
    v_add_u32 v178, s82, v178
    v_add_u32 v179, s82, v179
    s_add_u32 s58, s1, 1
    s_and_b32 s58, s58, 127
    s_sub_u32 s59, 383, s1
    s_cmp_ge_u32 s1, 128
    s_cselect_b32 s44, s59, s58
    s_cselect_b32 s43, 0x80008000, 0
    s_lshr_b32 s58, s51, 3
    s_lshl_b32 s58, s58, 5
    s_mul_i32 s59, s3, 7
    s_add_u32 s58, s58, s59
    s_lshl_b32 s58, s58, 7
    s_add_u32 s46, s58, 655360
    s_mul_i32 s59, s3, 28
    v_min_u32 v187, 6, v1
    v_lshlrev_b32 v187, 7, v187
    s_lshr_b32 s58, s3, 1
    s_add_u32 s45, s51, s58
    s_xor_b32 s58, s58, 1
    s_add_u32 s87, s51, s58
    s_mul_i32 s86, s45, 112
    s_add_u32 s86, s86, s59
    s_lshl_b32 s86, s86, 10
    s_add_u32 s86, s86, 7340032
    s_mul_i32 s87, s87, 112
    s_add_u32 s87, s87, s59
    s_lshl_b32 s87, s87, 10
    s_add_u32 s87, s87, 7340032
    s_lshl_b32 s45, s45, 10
    s_lshl_b32 s58, s52, 7
    s_add_u32 s45, s45, s58
    s_and_b32 s58, s3, 1
    s_lshl_b32 s58, s58, 6
    s_add_u32 s45, s45, s58
    v_and_b32 v188, 3, v1
    v_bfe_u32 v189, v1, 3, 1
    v_lshl_or_b32 v188, v189, 2, v188
    v_bfe_u32 v189, v1, 4, 1
    v_lshl_or_b32 v188, v189, 3, v188
    v_bfe_u32 v189, v1, 2, 1
    v_lshl_or_b32 v188, v189, 4, v188
    s_lshl_b32 s58, s52, 6
    s_and_b32 s59, s3, 1
    s_lshl_b32 s59, s59, 5
    s_add_u32 s58, s58, s59
    v_add_u32 v188, s58, v188
    v_cvt_f32_u32 v188, v188
    v_mul_f32 v188, 0x3b000000, v188
    v_lshrrev_b32 v189, 5, v1
    v_lshlrev_b32 v189, 2, v189
    v_cvt_f32_u32 v189, v189
    v_mul_f32 v189, v189, v188
    v_bfe_u32 v186, v1, 2, 2
    v_bfe_u32 v185, v1, 4, 2
    v_lshl_or_b32 v186, v185, 3, v186
    v_lshlrev_b32 v186, 16, v186
    v_and_b32 v185, 3, v1
    v_lshl_or_b32 v186, v185, 4, v186
    v_xor_b32 v184, 64, v171
    v_add_u32 v166, 66560, v178
    v_add_u32 v167, 66560, v179
    s_add_u32 s47, s45, 262144
    s_and_b32 s90, s2, 3
    s_lshl_b32 s90, s90, 2
    s_add_u32 s90, s90, s3
    s_lshl_b32 s90, s90, 13
    s_and_b32 s91, s2, 0xfc
    s_lshl_b32 s91, s91, 5
    s_add_u32 s90, s90, s91
    s_add_u32 s90, s90, 524288
    s_waitcnt vmcnt(8)
    v_mov_b32 v14, s40
    v_mov_b32 v15, 0
    s_mov_b64 exec, 1
    buffer_store_dword v14, v15, s[36:39], s90 offen sc1
    s_mov_b64 exec, -1
    s_waitcnt vmcnt(1)
    s_barrier
    v_mov_b32 v14, s40
    v_mov_b32 v15, 0
    s_mov_b64 exec, 1
    buffer_store_dword v14, v15, s[36:39], s50 offen sc1
    s_mov_b64 exec, -1
    s_cmp_eq_u32 s1, 255
    s_mov_b32 s0, 0x36000000
    s_cselect_b32 s0, 0x35800000, s0
    v_and_b32 v56, 15, v1
    v_lshrrev_b32 v57, 4, v1
    v_cvt_f32_u32 v56, v56
    v_cvt_f32_u32 v57, v57
    s_lshl_b32 s60, s3, 4
    v_cvt_f32_u32 v58, s60
    v_add_f32 v59, 0x00000000, v56
    s_add_u32 m0, s82, 33280
    s_bfe_u32 s84, s53, 262144
    s_lshl_b32 s84, s84, 15
    s_add_u32 s84, s84, s83
    buffer_load_dwordx4 v174, s[20:23], s84 offen offset:0 lds
    v_mul_f32 v59, 0x3d000000, v59
    v_mul_f32 v60, 4.0, v57
    v_mul_f32 v60, v60, v59
    v_fmamk_f32 v62, v59, 0x00000000, v60
    v_fmamk_f32 v63, v59, 0x3f800000, v60
    v_cos_f32 v64, v62
    v_cos_f32 v65, v63
    v_sin_f32 v66, v62
    buffer_load_dwordx4 v175, s[20:23], s84 offen offset:1024 lds
    v_sin_f32 v67, v63
    v_cvt_pk_bf16_f32 v62, v64, v65
    v_cvt_pk_bf16_f32 v63, v66, v67
    v_accvgpr_write_b32 a176, v62
    v_accvgpr_write_b32 a184, v63
    v_xor_b32 v63, 0x80008000, v63
    v_accvgpr_write_b32 a192, v63
    v_fmamk_f32 v68, v59, 0x40000000, v60
    v_fmamk_f32 v69, v59, 0x40400000, v60
    v_cos_f32 v70, v68
    buffer_load_dwordx4 v176, s[20:23], s84 offen offset:2048 lds
    v_cos_f32 v71, v69
    v_sin_f32 v72, v68
    v_sin_f32 v73, v69
    v_cvt_pk_bf16_f32 v68, v70, v71
    v_cvt_pk_bf16_f32 v69, v72, v73
    v_accvgpr_write_b32 a177, v68
    v_accvgpr_write_b32 a185, v69
    v_xor_b32 v69, 0x80008000, v69
    v_accvgpr_write_b32 a193, v69
    buffer_load_dwordx4 v177, s[20:23], s84 offen offset:3072 lds
    v_fmamk_f32 v62, v59, 0x41800000, v60
    v_fmamk_f32 v63, v59, 0x41880000, v60
    v_cos_f32 v64, v62
    v_cos_f32 v65, v63
    v_sin_f32 v66, v62
    v_sin_f32 v67, v63
    v_cvt_pk_bf16_f32 v62, v64, v65
    s_add_u32 m0, s82, 49664
    s_bfe_u32 s84, s53, 262148
    s_lshl_b32 s84, s84, 15
    s_add_u32 s84, s84, s83
    buffer_load_dwordx4 v174, s[20:23], s84 offen offset:0 lds
    v_cvt_pk_bf16_f32 v63, v66, v67
    v_accvgpr_write_b32 a178, v62
    v_accvgpr_write_b32 a186, v63
    v_xor_b32 v63, 0x80008000, v63
    v_accvgpr_write_b32 a194, v63
    v_fmamk_f32 v68, v59, 0x41900000, v60
    v_fmamk_f32 v69, v59, 0x41980000, v60
    v_cos_f32 v70, v68
    v_cos_f32 v71, v69
    v_sin_f32 v72, v68
    buffer_load_dwordx4 v175, s[20:23], s84 offen offset:1024 lds
    v_sin_f32 v73, v69
    v_cvt_pk_bf16_f32 v68, v70, v71
    v_cvt_pk_bf16_f32 v69, v72, v73
    v_accvgpr_write_b32 a179, v68
    v_accvgpr_write_b32 a187, v69
    v_xor_b32 v69, 0x80008000, v69
    v_accvgpr_write_b32 a195, v69
    v_add_f32 v59, 0x41800000, v56
    v_mul_f32 v59, 0x3d000000, v59
    buffer_load_dwordx4 v176, s[20:23], s84 offen offset:2048 lds
    v_mul_f32 v60, 4.0, v57
    v_mul_f32 v60, v60, v59
    v_fmamk_f32 v62, v59, 0x00000000, v60
    v_fmamk_f32 v63, v59, 0x3f800000, v60
    v_cos_f32 v64, v62
    v_cos_f32 v65, v63
    v_sin_f32 v66, v62
    v_sin_f32 v67, v63
    buffer_load_dwordx4 v177, s[20:23], s84 offen offset:3072 lds
    v_cvt_pk_bf16_f32 v62, v64, v65
    v_cvt_pk_bf16_f32 v63, v66, v67
    v_accvgpr_write_b32 a180, v62
    v_accvgpr_write_b32 a188, v63
    v_xor_b32 v63, 0x80008000, v63
    v_accvgpr_write_b32 a196, v63
    v_fmamk_f32 v68, v59, 0x40000000, v60
    v_fmamk_f32 v69, v59, 0x40400000, v60
    v_cos_f32 v70, v68
    v_cos_f32 v71, v69
    s_add_u32 m0, s82, 0
    s_bfe_u32 s84, s53, 262152
    s_lshl_b32 s84, s84, 15
    s_add_u32 s84, s84, s83
    buffer_load_dwordx4 v174, s[20:23], s84 offen offset:0 lds
    v_sin_f32 v72, v68
    v_sin_f32 v73, v69
    v_cvt_pk_bf16_f32 v68, v70, v71
    v_cvt_pk_bf16_f32 v69, v72, v73
    v_accvgpr_write_b32 a181, v68
    v_accvgpr_write_b32 a189, v69
    v_xor_b32 v69, 0x80008000, v69
    v_accvgpr_write_b32 a197, v69
    v_fmamk_f32 v62, v59, 0x41800000, v60
    buffer_load_dwordx4 v175, s[20:23], s84 offen offset:1024 lds
    v_fmamk_f32 v63, v59, 0x41880000, v60
    v_cos_f32 v64, v62
    v_cos_f32 v65, v63
    v_sin_f32 v66, v62
    v_sin_f32 v67, v63
    v_cvt_pk_bf16_f32 v62, v64, v65
    v_cvt_pk_bf16_f32 v63, v66, v67
    v_accvgpr_write_b32 a182, v62
    buffer_load_dwordx4 v176, s[20:23], s84 offen offset:2048 lds
    v_accvgpr_write_b32 a190, v63
    v_xor_b32 v63, 0x80008000, v63
    v_accvgpr_write_b32 a198, v63
    v_fmamk_f32 v68, v59, 0x41900000, v60
    v_fmamk_f32 v69, v59, 0x41980000, v60
    v_cos_f32 v70, v68
    v_cos_f32 v71, v69
    v_sin_f32 v72, v68
    buffer_load_dwordx4 v177, s[20:23], s84 offen offset:3072 lds
    v_sin_f32 v73, v69
    v_cvt_pk_bf16_f32 v68, v70, v71
    v_cvt_pk_bf16_f32 v69, v72, v73
    v_accvgpr_write_b32 a183, v68
    v_accvgpr_write_b32 a191, v69
    v_xor_b32 v69, 0x80008000, v69
    v_accvgpr_write_b32 a199, v69
    v_add_f32 v59, v58, v56
    v_mul_f32 v59, 0x3c800000, v59
    v_mul_f32 v60, 0x41000000, v57
    v_mul_f32 v60, v60, v59
    s_add_u32 m0, s82, 16384
    s_bfe_u32 s84, s53, 262156
    s_lshl_b32 s84, s84, 15
    s_add_u32 s84, s84, s83
    buffer_load_dwordx4 v174, s[20:23], s84 offen offset:0 lds
    v_fmamk_f32 v62, v59, 0x00000000, v60
    v_fmamk_f32 v63, v59, 0x3f800000, v60
    v_cos_f32 v64, v62
    v_cos_f32 v65, v63
    v_sin_f32 v66, v62
    v_sin_f32 v67, v63
    v_cvt_pk_bf16_f32 v62, v64, v65
    v_cvt_pk_bf16_f32 v63, v66, v67
    buffer_load_dwordx4 v175, s[20:23], s84 offen offset:1024 lds
    v_accvgpr_write_b32 a200, v62
    v_accvgpr_write_b32 a208, v63
    v_xor_b32 v63, 0x80008000, v63
    v_accvgpr_write_b32 a216, v63
    v_fmamk_f32 v68, v59, 0x40000000, v60
    v_fmamk_f32 v69, v59, 0x40400000, v60
    v_cos_f32 v70, v68
    v_cos_f32 v71, v69
    v_sin_f32 v72, v68
    buffer_load_dwordx4 v176, s[20:23], s84 offen offset:2048 lds
    v_sin_f32 v73, v69
    v_cvt_pk_bf16_f32 v68, v70, v71
    v_cvt_pk_bf16_f32 v69, v72, v73
    v_accvgpr_write_b32 a201, v68
    v_accvgpr_write_b32 a209, v69
    v_xor_b32 v69, 0x80008000, v69
    v_accvgpr_write_b32 a217, v69
    v_fmamk_f32 v62, v59, 0x40800000, v60
    v_fmamk_f32 v63, v59, 0x40a00000, v60
    v_cos_f32 v64, v62
    buffer_load_dwordx4 v177, s[20:23], s84 offen offset:3072 lds
    v_cos_f32 v65, v63
    v_sin_f32 v66, v62
    v_sin_f32 v67, v63
    v_cvt_pk_bf16_f32 v62, v64, v65
    v_cvt_pk_bf16_f32 v63, v66, v67
    v_accvgpr_write_b32 a202, v62
    v_accvgpr_write_b32 a210, v63
    s_add_u32 m0, s82, 66560
    s_bfe_u32 s84, s53, 262160
    s_lshl_b32 s84, s84, 15
    s_add_u32 s84, s84, s83
    buffer_load_dwordx4 v174, s[20:23], s84 offen offset:0 lds
    v_xor_b32 v63, 0x80008000, v63
    v_accvgpr_write_b32 a218, v63
    v_fmamk_f32 v68, v59, 0x40c00000, v60
    v_fmamk_f32 v69, v59, 0x40e00000, v60
    v_cos_f32 v70, v68
    v_cos_f32 v71, v69
    v_sin_f32 v72, v68
    v_sin_f32 v73, v69
    buffer_load_dwordx4 v175, s[20:23], s84 offen offset:1024 lds
    v_cvt_pk_bf16_f32 v68, v70, v71
    v_cvt_pk_bf16_f32 v69, v72, v73
    v_accvgpr_write_b32 a203, v68
    v_accvgpr_write_b32 a211, v69
    v_xor_b32 v69, 0x80008000, v69
    v_accvgpr_write_b32 a219, v69
    v_fmamk_f32 v62, v59, 0x42000000, v60
    v_fmamk_f32 v63, v59, 0x42040000, v60
    v_cos_f32 v64, v62
    v_cos_f32 v65, v63
    buffer_load_dwordx4 v176, s[20:23], s84 offen offset:2048 lds
    v_sin_f32 v66, v62
    v_sin_f32 v67, v63
    v_cvt_pk_bf16_f32 v62, v64, v65
    v_cvt_pk_bf16_f32 v63, v66, v67
    v_accvgpr_write_b32 a204, v62
    v_accvgpr_write_b32 a212, v63
    v_xor_b32 v63, 0x80008000, v63
    v_accvgpr_write_b32 a220, v63
    v_fmamk_f32 v68, v59, 0x42080000, v60
    buffer_load_dwordx4 v177, s[20:23], s84 offen offset:3072 lds
    v_fmamk_f32 v69, v59, 0x420c0000, v60
    v_cos_f32 v70, v68
    v_cos_f32 v71, v69
    v_sin_f32 v72, v68
    v_sin_f32 v73, v69
    v_cvt_pk_bf16_f32 v68, v70, v71
    v_cvt_pk_bf16_f32 v69, v72, v73
    v_accvgpr_write_b32 a205, v68
    s_add_u32 m0, s82, 82944
    s_bfe_u32 s84, s53, 262164
    s_lshl_b32 s84, s84, 15
    s_add_u32 s84, s84, s83
    buffer_load_dwordx4 v174, s[20:23], s84 offen offset:0 lds
    v_accvgpr_write_b32 a213, v69
    v_xor_b32 v69, 0x80008000, v69
    v_accvgpr_write_b32 a221, v69
    v_fmamk_f32 v62, v59, 0x42100000, v60
    v_fmamk_f32 v63, v59, 0x42140000, v60
    v_cos_f32 v64, v62
    v_cos_f32 v65, v63
    v_sin_f32 v66, v62
    buffer_load_dwordx4 v175, s[20:23], s84 offen offset:1024 lds
    v_sin_f32 v67, v63
    v_cvt_pk_bf16_f32 v62, v64, v65
    v_cvt_pk_bf16_f32 v63, v66, v67
    v_accvgpr_write_b32 a206, v62
    v_accvgpr_write_b32 a214, v63
    v_xor_b32 v63, 0x80008000, v63
    v_accvgpr_write_b32 a222, v63
    v_fmamk_f32 v68, v59, 0x42180000, v60
    v_fmamk_f32 v69, v59, 0x421c0000, v60
    v_cos_f32 v70, v68
    buffer_load_dwordx4 v176, s[20:23], s84 offen offset:2048 lds
    v_cos_f32 v71, v69
    v_sin_f32 v72, v68
    v_sin_f32 v73, v69
    v_cvt_pk_bf16_f32 v68, v70, v71
    buffer_load_dword v182, v172, s[36:39], s80 offen sc1
    v_cvt_pk_bf16_f32 v69, v72, v73
    v_accvgpr_write_b32 a207, v68
    v_accvgpr_write_b32 a215, v69
    v_xor_b32 v69, 0x80008000, v69
    v_accvgpr_write_b32 a223, v69
    buffer_load_dwordx4 v177, s[20:23], s84 offen offset:3072 lds
    v_fma_f32 v61, v57, 4.0, v58
    v_add_f32 v59, 0x00000000, v56
    v_mul_f32 v59, 0x3a000000, v59
    v_mul_f32 v60, v59, v61
    v_fmamk_f32 v62, v59, 0x00000000, v60
    buffer_load_dword v183, v173, s[36:39], s81 offen sc1
    v_fmamk_f32 v63, v59, 0x3f800000, v60
    v_fmamk_f32 v64, v59, 0x40000000, v60
    v_fmamk_f32 v65, v59, 0x40400000, v60
    v_cos_f32 v66, v62
    v_cos_f32 v67, v63
    s_add_u32 m0, s82, 99840
    s_bfe_u32 s84, s85, 262152
    s_lshl_b32 s84, s84, 15
    s_add_u32 s84, s84, s83
    buffer_load_dwordx4 v174, s[20:23], s84 offen offset:0 lds
    v_cos_f32 v68, v64
    v_cos_f32 v69, v65
    v_sin_f32 v70, v62
    v_sin_f32 v71, v63
    v_sin_f32 v72, v64
    v_sin_f32 v73, v65
    buffer_load_dwordx4 v175, s[20:23], s84 offen offset:1024 lds
    v_accvgpr_write_b32 a224, v66
    v_accvgpr_write_b32 a225, v67
    v_accvgpr_write_b32 a226, v68
    v_accvgpr_write_b32 a227, v69
    v_accvgpr_write_b32 a232, v70
    v_accvgpr_write_b32 a233, v71
    v_accvgpr_write_b32 a234, v72
    v_accvgpr_write_b32 a235, v73
    v_add_f32 v59, 0x41800000, v56
    v_mul_f32 v59, 0x3a000000, v59
    buffer_load_dwordx4 v176, s[20:23], s84 offen offset:2048 lds
    v_mul_f32 v60, v59, v61
    v_fmamk_f32 v62, v59, 0x00000000, v60
    v_fmamk_f32 v63, v59, 0x3f800000, v60
    v_fmamk_f32 v64, v59, 0x40000000, v60
    v_fmamk_f32 v65, v59, 0x40400000, v60
    v_cos_f32 v66, v62
    v_cos_f32 v67, v63
    v_cos_f32 v68, v64
    v_cos_f32 v69, v65
    buffer_load_dwordx4 v177, s[20:23], s84 offen offset:3072 lds
    v_sin_f32 v70, v62
    v_sin_f32 v71, v63
    v_sin_f32 v72, v64
    v_sin_f32 v73, v65
    v_accvgpr_write_b32 a228, v66
    v_accvgpr_write_b32 a229, v67
    v_accvgpr_write_b32 a230, v68
    s_add_u32 m0, s82, 116224
    s_bfe_u32 s84, s85, 262156
    s_lshl_b32 s84, s84, 15
    s_add_u32 s84, s84, s83
    buffer_load_dwordx4 v174, s[20:23], s84 offen offset:0 lds
    v_accvgpr_write_b32 a231, v69
    v_accvgpr_write_b32 a236, v70
    v_accvgpr_write_b32 a237, v71
    v_accvgpr_write_b32 a238, v72
    v_accvgpr_write_b32 a239, v73
    v_add_f32 v59, v58, v56
    v_mul_f32 v59, 0x3a000000, v59
    v_mul_f32 v60, 4.0, v57
    v_mul_f32 v60, v60, v59
    v_fmamk_f32 v62, v59, 0x00000000, v60
    v_fmamk_f32 v63, v59, 0x3f800000, v60
    buffer_load_dwordx4 v175, s[20:23], s84 offen offset:1024 lds
    v_fmamk_f32 v64, v59, 0x40000000, v60
    v_fmamk_f32 v65, v59, 0x40400000, v60
    v_cos_f32 v66, v62
    v_cos_f32 v67, v63
    v_cos_f32 v68, v64
    v_cos_f32 v69, v65
    v_sin_f32 v70, v62
    buffer_load_dwordx4 v176, s[20:23], s84 offen offset:2048 lds
    v_sin_f32 v71, v63
    v_sin_f32 v72, v64
    v_sin_f32 v73, v65
    v_mul_f32 v66, s0, v66
    v_mul_f32 v67, s0, v67
    v_mul_f32 v68, s0, v68
    v_mul_f32 v69, s0, v69
    v_mul_f32 v70, s0, v70
    buffer_load_dwordx4 v177, s[20:23], s84 offen offset:3072 lds
    v_mul_f32 v71, s0, v71
    v_mul_f32 v72, s0, v72
    v_mul_f32 v73, s0, v73
    v_accvgpr_write_b32 a240, v66
    v_accvgpr_write_b32 a241, v67
    v_accvgpr_write_b32 a242, v68
    v_accvgpr_write_b32 a243, v69
    v_accvgpr_write_b32 a248, v70
    v_accvgpr_write_b32 a249, v71
    v_accvgpr_write_b32 a250, v72
    v_accvgpr_write_b32 a251, v73
    v_fmamk_f32 v62, v59, 0x41800000, v60
    v_fmamk_f32 v63, v59, 0x41880000, v60
    v_fmamk_f32 v64, v59, 0x41900000, v60
    v_fmamk_f32 v65, v59, 0x41980000, v60
    v_cos_f32 v66, v62
    v_cos_f32 v67, v63
    v_cos_f32 v68, v64
    v_cos_f32 v69, v65
    v_sin_f32 v70, v62
    v_sin_f32 v71, v63
    v_sin_f32 v72, v64
    v_sin_f32 v73, v65
    v_mul_f32 v66, s0, v66
    v_mul_f32 v67, s0, v67
    v_mul_f32 v68, s0, v68
    v_mul_f32 v69, s0, v69
    v_mul_f32 v70, s0, v70
    v_mul_f32 v71, s0, v71
    v_mul_f32 v72, s0, v72
    v_mul_f32 v73, s0, v73
    v_accvgpr_write_b32 a244, v66
    v_accvgpr_write_b32 a245, v67
    v_accvgpr_write_b32 a246, v68
    v_accvgpr_write_b32 a247, v69
    v_accvgpr_write_b32 a252, v70
    v_accvgpr_write_b32 a253, v71
    v_accvgpr_write_b32 a254, v72
    v_accvgpr_write_b32 a255, v73
    s_waitcnt vmcnt(10)
    v_cmp_ne_u32 vcc, s40, v182
    s_nop 0
    s_cmp_lg_u64 vcc, 0
    s_cbranch_scc1 L_slow4
L_back4:
    s_waitcnt vmcnt(8)
    v_cmp_ne_u32 vcc, s40, v183
    s_nop 0
    s_cmp_lg_u64 vcc, 0
    s_cbranch_scc1 L_slow5
L_back5:
    s_lshl_b32 s90, s1, 13
    s_add_u32 s91, s90, 1048576
    buffer_load_dwordx4 v[96:99], v168, s[36:39], s91 offen sc1
    s_add_u32 s91, s90, 1052672
    buffer_load_dwordx4 v[100:103], v168, s[36:39], s91 offen sc1
    s_add_u32 s91, s90, 3145728
    buffer_load_dwordx4 v[104:107], v169, s[36:39], s91 offen sc1
    buffer_load_dwordx4 v[108:111], v169, s[36:39], s91 offen offset:16 sc1
    ds_read_b64_tr_b16 v[192:193], v178 offset:33280
    ds_read_b64_tr_b16 v[194:195], v178 offset:33792
    ds_read_b64_tr_b16 v[196:197], v179 offset:33280
    ds_read_b64_tr_b16 v[198:199], v179 offset:33792
    ds_read_b64_tr_b16 v[200:201], v178 offset:35328
    ds_read_b64_tr_b16 v[202:203], v178 offset:35840
    ds_read_b64_tr_b16 v[204:205], v179 offset:35328
    ds_read_b64_tr_b16 v[206:207], v179 offset:35840
    ds_read_b64_tr_b16 v[208:209], v178 offset:49664
    ds_read_b64_tr_b16 v[210:211], v178 offset:50176
    ds_read_b64_tr_b16 v[212:213], v179 offset:49664
    ds_read_b64_tr_b16 v[214:215], v179 offset:50176
    ds_read_b64_tr_b16 v[216:217], v178 offset:51712
    ds_read_b64_tr_b16 v[218:219], v178 offset:52224
    ds_read_b64_tr_b16 v[220:221], v179 offset:51712
    ds_read_b64_tr_b16 v[222:223], v179 offset:52224
    ds_read_b64_tr_b16 v[224:225], v178 offset:0
    ds_read_b64_tr_b16 v[226:227], v178 offset:512
    ds_read_b64_tr_b16 v[228:229], v179 offset:0
    ds_read_b64_tr_b16 v[230:231], v179 offset:512
    ds_read_b64_tr_b16 v[232:233], v178 offset:2048
    ds_read_b64_tr_b16 v[234:235], v178 offset:2560
    ds_read_b64_tr_b16 v[236:237], v179 offset:2048
    ds_read_b64_tr_b16 v[238:239], v179 offset:2560
    ds_read_b64_tr_b16 v[240:241], v178 offset:16384
    ds_read_b64_tr_b16 v[242:243], v178 offset:16896
    ds_read_b64_tr_b16 v[244:245], v179 offset:16384
    ds_read_b64_tr_b16 v[246:247], v179 offset:16896
    ds_read_b64_tr_b16 v[248:249], v178 offset:18432
    ds_read_b64_tr_b16 v[250:251], v178 offset:18944
    ds_read_b64_tr_b16 v[252:253], v179 offset:18432
    ds_read_b64_tr_b16 v[254:255], v179 offset:18944
    ds_read_b64_tr_b16 a[128:129], v166 offset:0
    ds_read_b64_tr_b16 a[130:131], v166 offset:512
    ds_read_b64_tr_b16 a[132:133], v167 offset:0
    ds_read_b64_tr_b16 a[134:135], v167 offset:512
    ds_read_b64_tr_b16 a[136:137], v166 offset:2048
    ds_read_b64_tr_b16 a[138:139], v166 offset:2560
    ds_read_b64_tr_b16 a[140:141], v167 offset:2048
    ds_read_b64_tr_b16 a[142:143], v167 offset:2560
    ds_read_b64_tr_b16 a[144:145], v166 offset:16384
    ds_read_b64_tr_b16 a[146:147], v166 offset:16896
    ds_read_b64_tr_b16 a[148:149], v167 offset:16384
    ds_read_b64_tr_b16 a[150:151], v167 offset:16896
    ds_read_b64_tr_b16 a[152:153], v166 offset:18432
    ds_read_b64_tr_b16 a[154:155], v166 offset:18944
    ds_read_b64_tr_b16 a[156:157], v167 offset:18432
    ds_read_b64_tr_b16 a[158:159], v167 offset:18944
    s_waitcnt lgkmcnt(0)
    s_add_u32 m0, s82, 33280
    s_bfe_u32 s84, s53, 262168
    s_lshl_b32 s84, s84, 15
    s_add_u32 s84, s84, s83
    buffer_load_dwordx4 v174, s[20:23], s84 offen offset:0 lds
    buffer_load_dwordx4 v175, s[20:23], s84 offen offset:1024 lds
    buffer_load_dwordx4 v176, s[20:23], s84 offen offset:2048 lds
    buffer_load_dwordx4 v177, s[20:23], s84 offen offset:3072 lds
    s_add_u32 m0, s82, 49664
    s_bfe_u32 s84, s53, 262172
    s_lshl_b32 s84, s84, 15
    s_add_u32 s84, s84, s83
    buffer_load_dwordx4 v174, s[20:23], s84 offen offset:0 lds
    buffer_load_dwordx4 v175, s[20:23], s84 offen offset:1024 lds
    buffer_load_dwordx4 v176, s[20:23], s84 offen offset:2048 lds
    buffer_load_dwordx4 v177, s[20:23], s84 offen offset:3072 lds
    s_add_u32 m0, s82, 66560
    s_bfe_u32 s84, s85, 262144
    s_lshl_b32 s84, s84, 15
    s_add_u32 s84, s84, s83
    buffer_load_dwordx4 v174, s[20:23], s84 offen offset:0 lds
    buffer_load_dwordx4 v175, s[20:23], s84 offen offset:1024 lds
    buffer_load_dwordx4 v176, s[20:23], s84 offen offset:2048 lds
    buffer_load_dwordx4 v177, s[20:23], s84 offen offset:3072 lds
    s_add_u32 m0, s82, 82944
    s_bfe_u32 s84, s85, 262148
    s_lshl_b32 s84, s84, 15
    s_add_u32 s84, s84, s83
    buffer_load_dwordx4 v174, s[20:23], s84 offen offset:0 lds
    buffer_load_dwordx4 v175, s[20:23], s84 offen offset:1024 lds
    buffer_load_dwordx4 v176, s[20:23], s84 offen offset:2048 lds
    buffer_load_dwordx4 v177, s[20:23], s84 offen offset:3072 lds
    buffer_load_dword v13, v187, s[36:39], s46 offen sc1
    s_or_b32 s50, s50, 0x4000
    s_waitcnt vmcnt(0) lgkmcnt(0)
    s_branch L_join
L_slow0:
    s_cmp_eq_u32 s54, 0
    s_cbranch_scc1 L_back0
    s_sub_u32 s54, s54, 1
    s_sleep 4
    s_lshr_b32 s56, s64, 1
    s_and_b32 s56, s56, 0x7e00
    s_add_u32 s56, s56, 65536
    buffer_load_dwordx4 v[96:99], v12, s[36:39], s56 offen sc1
    s_lshr_b32 s56, s65, 1
    s_and_b32 s56, s56, 0x7e00
    s_add_u32 s56, s56, 65536
    buffer_load_dwordx4 v[100:103], v12, s[36:39], s56 offen sc1
    s_lshr_b32 s56, s66, 1
    s_and_b32 s56, s56, 0x7e00
    s_add_u32 s56, s56, 65536
    buffer_load_dwordx4 v[104:107], v12, s[36:39], s56 offen sc1
    s_lshr_b32 s56, s67, 1
    s_and_b32 s56, s56, 0x7e00
    s_add_u32 s56, s56, 65536
    buffer_load_dwordx4 v[108:111], v12, s[36:39], s56 offen sc1
    s_lshr_b32 s56, s68, 1
    s_and_b32 s56, s56, 0x7e00
    s_add_u32 s56, s56, 65536
    buffer_load_dwordx4 v[112:115], v12, s[36:39], s56 offen sc1
    s_lshr_b32 s56, s69, 1
    s_and_b32 s56, s56, 0x7e00
    s_add_u32 s56, s56, 65536
    buffer_load_dwordx4 v[116:119], v12, s[36:39], s56 offen sc1
    s_lshr_b32 s56, s70, 1
    s_and_b32 s56, s56, 0x7e00
    s_add_u32 s56, s56, 65536
    buffer_load_dwordx4 v[120:123], v12, s[36:39], s56 offen sc1
    s_lshr_b32 s56, s71, 1
    s_and_b32 s56, s56, 0x7e00
    s_add_u32 s56, s56, 65536
    buffer_load_dwordx4 v[124:127], v12, s[36:39], s56 offen sc1
    s_waitcnt vmcnt(0)
    v_cmp_ne_u32 vcc, s40, v99
    v_cmp_ne_u32 s[62:63], s40, v103
    s_nop 0
    s_or_b64 vcc, vcc, s[62:63]
    v_cmp_ne_u32 s[62:63], s40, v107
    s_nop 0
    s_or_b64 vcc, vcc, s[62:63]
    v_cmp_ne_u32 s[62:63], s40, v111
    s_nop 0
    s_or_b64 vcc, vcc, s[62:63]
    v_cmp_ne_u32 s[62:63], s40, v115
    s_nop 0
    s_or_b64 vcc, vcc, s[62:63]
    v_cmp_ne_u32 s[62:63], s40, v119
    s_nop 0
    s_or_b64 vcc, vcc, s[62:63]
    v_cmp_ne_u32 s[62:63], s40, v123
    s_nop 0
    s_or_b64 vcc, vcc, s[62:63]
    v_cmp_ne_u32 s[62:63], s40, v127
    s_nop 0
    s_or_b64 vcc, vcc, s[62:63]
    s_cmp_lg_u64 vcc, 0
    s_cbranch_scc1 L_slow0
    s_nop 4
    s_branch L_back0
L_slow1:
    s_cmp_eq_u32 s54, 0
    s_cbranch_scc1 L_back1
    s_sub_u32 s54, s54, 1
    s_sleep 4
    buffer_load_dword v183, v173, s[36:39], s81 offen sc1
    s_waitcnt vmcnt(0)
    v_cmp_ne_u32 vcc, s40, v183
    s_nop 0
    s_cmp_lg_u64 vcc, 0
    s_cbranch_scc1 L_slow1
    s_nop 4
    s_branch L_back1
L_slow2:
    s_cmp_eq_u32 s54, 0
    s_cbranch_scc1 L_back2
    s_sub_u32 s54, s54, 1
    s_sleep 4
    buffer_load_dword v182, v172, s[36:39], s80 offen sc1
    s_waitcnt vmcnt(0)
    v_cmp_ne_u32 vcc, s40, v182
    s_nop 0
    s_cmp_lg_u64 vcc, 0
    s_cbranch_scc1 L_slow2
    s_nop 4
    s_branch L_back2
L_slow3:
    s_cmp_eq_u32 s54, 0
    s_cbranch_scc1 L_back3
    s_sub_u32 s54, s54, 1
    s_sleep 4
    buffer_load_dwordx4 v[80:83], v2, s[36:39], s79 offen sc1
    s_waitcnt vmcnt(0)
    v_cmp_ne_u32 vcc, s40, v83
    s_nop 0
    s_cmp_lg_u64 vcc, 0
    s_cbranch_scc1 L_slow3
    s_nop 4
    s_branch L_back3
L_slow4:
    s_cmp_eq_u32 s54, 0
    s_cbranch_scc1 L_back4
    s_sub_u32 s54, s54, 1
    s_sleep 6
    buffer_load_dword v182, v172, s[36:39], s80 offen sc1
    s_waitcnt vmcnt(0)
    v_cmp_ne_u32 vcc, s40, v182
    s_nop 0
    s_cmp_lg_u64 vcc, 0
    s_cbranch_scc1 L_slow4
    s_nop 4
    s_branch L_back4
L_slow5:
    s_cmp_eq_u32 s54, 0
    s_cbranch_scc1 L_back5
    s_sub_u32 s54, s54, 1
    s_sleep 6
    buffer_load_dword v183, v173, s[36:39], s81 offen sc1
    s_waitcnt vmcnt(0)
    v_cmp_ne_u32 vcc, s40, v183
    s_nop 0
    s_cmp_lg_u64 vcc, 0
    s_cbranch_scc1 L_slow5
    s_nop 4
    s_branch L_back5
L_slow6:
    s_cmp_eq_u32 s54, 0
    s_cbranch_scc1 L_back6
    s_sub_u32 s54, s54, 1
    s_sleep 8
    buffer_load_dword v13, v187, s[36:39], s46 offen sc1
    s_waitcnt vmcnt(0)
    v_cmp_ne_u32 vcc, s40, v13
    s_nop 0
    s_cmp_lg_u64 vcc, 0
    s_cbranch_scc1 L_slow6
    s_nop 4
    s_branch L_back6
L_slow7:
    s_cmp_eq_u32 s54, 0
    s_cbranch_scc1 L_back7
    s_sub_u32 s54, s54, 1
    s_sleep 8
    s_add_u32 s62, s46, 0x8000
    buffer_load_dword v13, v187, s[36:39], s62 offen sc1
    s_waitcnt vmcnt(0)
    v_cmp_ne_u32 vcc, s40, v13
    s_nop 0
    s_cmp_lg_u64 vcc, 0
    s_cbranch_scc1 L_slow7
    s_nop 4
    s_branch L_back7
L_slow8:
    s_cmp_eq_u32 s54, 0
    s_cbranch_scc1 L_back8
    s_sub_u32 s54, s54, 1
    s_sleep 4
    s_add_u32 s62, s46, 0x10000
    buffer_load_dword v13, v187, s[36:39], s62 offen sc1
    s_waitcnt vmcnt(0)
    v_cmp_ne_u32 vcc, s40, v13
    s_nop 0
    s_cmp_lg_u64 vcc, 0
    s_cbranch_scc1 L_slow8
    s_nop 4
    s_branch L_back8
L_slow9:
    s_cmp_eq_u32 s54, 0
    s_cbranch_scc1 L_back9
    s_sub_u32 s54, s54, 1
    s_sleep 4
    buffer_load_dword v14, v11, s[36:39], s80 offen sc1
    s_waitcnt vmcnt(0)
    v_cmp_ne_u32 vcc, s40, v14
    s_nop 0
    s_cmp_lg_u64 vcc, 0
    s_cbranch_scc1 L_slow9
    s_nop 4
    s_branch L_back9
    s_endpgm
L_code_end:
.section .rodata,"a"
.p2align 6
.amdhsa_kernel recurrent_scan__spectral_gfnet__glu_gated_geglu__prompt_kernel
  .amdhsa_next_free_vgpr 512
  .amdhsa_next_free_sgpr 102
  .amdhsa_accum_offset 256
  .amdhsa_group_segment_fixed_size 0
  .amdhsa_kernarg_size 80
  .amdhsa_user_sgpr_count 2
  .amdhsa_user_sgpr_kernarg_segment_ptr 1
  .amdhsa_system_sgpr_workgroup_id_x 1
.end_amdhsa_kernel
```
